```python
import torch

def _softmax(x, axis=-1):
    return torch.softmax(x, dim=axis)
def _gelu(x):
    return torch.nn.functional.gelu(x, approximate="tanh")
def _silu(x):
    return torch.nn.functional.silu(x)
def _sigmoid(x):
    return torch.sigmoid(x)
def _layernorm(x, axis=-1, eps=1e-5):
    m = x.mean(dim=axis, keepdim=True)
    v = x.var(dim=axis, keepdim=True, unbiased=False)
    return (x - m) / torch.sqrt(v + eps)
def _scatter_add(tgt, idx, src, axis=0):
    return tgt.clone().index_add_(axis, idx, src)
def _segment_sum(src, seg, n):
    out = torch.zeros((n,) + src.shape[1:], dtype=src.dtype)
    return out.index_add_(0, seg, src)
def _pad(x, pw):
    flat = tuple(v for pair in reversed(pw) for v in pair)
    return torch.nn.functional.pad(x, flat)

kernel_name = 'sequential_preLN__ssm_conv_s4d__mixer_token_mlp__prompt'

def setup_inputs():

    _w = (lambda a: (lambda t: t.to(torch.bfloat16) if t.is_floating_point() else t)(torch.as_tensor(a)))
    def _A_setup():
        Bsz, L, D, N = 1, 2048, 640, 192
        return {
            "u": _w((lambda *s: torch.randn(*s, dtype=torch.bfloat16) * 0.05)(Bsz, L, D)),
            "log_A_real": _w((lambda *s: torch.randn(*s, dtype=torch.bfloat16) * 6.4)(D, N) * 0.5),
            "A_imag": _w((lambda *s: torch.randn(*s, dtype=torch.bfloat16) * 0.05)(D, N) * 3.14),
            "C_real": _w((lambda *s: torch.randn(*s, dtype=torch.bfloat16) * 0.05)(D, N) / N ** 0.5),
            "C_imag": _w((lambda *s: torch.randn(*s, dtype=torch.bfloat16) * 0.05)(D, N) / N ** 0.5),
            "log_dt": _w((lambda *s: torch.randn(*s, dtype=torch.bfloat16) * 0.05)(D) * 0.5 - 4.0),
            "D_skip": _w((lambda *s: torch.randn(*s, dtype=torch.bfloat16) * 0.05)(D)),
        }
    _A_in = _A_setup()

    def _B_setup():
        B, S, D, F = 1, 2048, 640, 1536
        return {
            "x": _w((lambda *s: torch.randn(*s, dtype=torch.bfloat16) * 0.05)(B, S, D)),
            "w1": _w((lambda *s: torch.randn(*s, dtype=torch.bfloat16) * 0.4)(S, F) * (S ** -0.5)),
            "b1": _w((lambda *s: torch.randn(*s, dtype=torch.bfloat16) * 12.8)(F) * 0.02),
            "w2": _w((lambda *s: torch.randn(*s, dtype=torch.bfloat16) * 0.2)(F, S) * (F ** -0.5)),
            "b2": _w((lambda *s: torch.randn(*s, dtype=torch.bfloat16) * 3.2)(S) * 0.02),
        }
    _B_in = _B_setup()

    return {
        "A_u": _A_in["u"],
        "A_log_A_real": _A_in["log_A_real"],
        "A_A_imag": _A_in["A_imag"],
        "A_C_real": _A_in["C_real"],
        "A_C_imag": _A_in["C_imag"],
        "A_log_dt": _A_in["log_dt"],
        "A_D_skip": _A_in["D_skip"],
        "B_x": _B_in["x"],
        "B_w1": _B_in["w1"],
        "B_b1": _B_in["b1"],
        "B_w2": _B_in["w2"],
        "B_b2": _B_in["b2"],
    }

def reference(A_u, A_log_A_real, A_A_imag, A_C_real, A_C_imag, A_log_dt, A_D_skip, B_x, B_w1, B_b1, B_w2, B_b2):
    def _A_ref(u, log_A_real, A_imag, C_real, C_imag, log_dt, D_skip):
        L = u.shape[1]
        dt = torch.exp(log_dt)
        A = -torch.exp(log_A_real) + 1j * A_imag
        C = (C_real + 1j * C_imag) * dt[:, None]
        pos = (lambda x, dt: x.to(dt))(torch.arange(L), log_dt.dtype)
        P = torch.exp((A * dt[:, None])[:, :, None] * pos[None, None, :])
        K = 2.0 * torch.einsum("dn,dnl->dl", C, P).real
        L2 = 2 * L
        u_t = (lambda x, *d: x.permute(*d))(u, 0, 2, 1)
        Kf = (lambda x, *a, **k: torch.fft.rfft(x.float(), *a, **k))(K, L2)
        Uf = (lambda x, *a, **k: torch.fft.rfft(x.float(), *a, **k))(u_t, L2)
        y = (lambda x, *a, **k: torch.fft.irfft(x, *a, **k).to(torch.bfloat16))(Uf * Kf[None, :, :], L2)[:, :, :L]
        y = (lambda x, *d: x.permute(*d))(y, 0, 2, 1)
        return y + u * D_skip[None, None, :]

    def _B_ref(x, w1, b1, w2, b2):
        B, S, D = x.shape
        h = _layernorm(x, axis=-1)
        u = torch.einsum("bsd,sf->bdf", h, w1) + b1
        u = _gelu(u)
        y = torch.einsum("bdf,fs->bds", u, w2) + b2
        return (lambda x, *d: x.permute(*d))(y, 0, 2, 1)

    x = A_u
    h = x + _A_ref(_layernorm(x, axis=-1), A_log_A_real, A_A_imag, A_C_real, A_C_imag, A_log_dt, A_D_skip)
    h2 = h + _B_ref(_layernorm(h, axis=-1), B_w1, B_b1, B_w2, B_b2)
    return h2
```

```asm
; @launch kernel=k0_ln1_kernel grid=(256,1,1) block=(256,1,1) lds=12800
; @launch kernel=kc_kgenconv_kernel grid=(640,1,1) block=(256,1,1) lds=43008
; @launch kernel=k3_ln2_kernel grid=(256,1,1) block=(256,1,1) lds=12800
; @launch kernel=k4_gemm1_kernel grid=(240,1,1) block=(256,1,1) lds=40960
; @launch kernel=k5_gemm2_kernel grid=(320,1,1) block=(256,1,1) lds=40960
.amdgcn_target "amdgcn-amd-amdhsa--gfx950"
.text
.globl k0_ln1_kernel
.p2align 8
.type k0_ln1_kernel,@function
k0_ln1_kernel:
    s_cmp_ge_u32 s2, 256
    s_cbranch_scc1 L_k0_end
    s_load_dwordx2 s[4:5], s[0:1], 0
    s_load_dwordx2 s[6:7], s[0:1], 112
    v_and_b32 v1, 63, v0
    v_lshrrev_b32 v2, 6, v0
    s_mul_i32 s16, s2, 10240
    s_waitcnt lgkmcnt(0)
    s_mov_b32 s8, s4
    s_mov_b32 s9, s5
    s_mov_b32 s10, 2621440
    s_mov_b32 s11, 0x00020000
    s_mov_b32 s12, s6
    s_mov_b32 s13, s7
    s_mov_b32 s14, 2621440
    s_mov_b32 s15, 0x00020000
    v_lshlrev_b32 v3, 2, v1
    v_mul_u32_u24 v11, 2560, v2
    v_add_u32 v3, v3, v11
    buffer_load_dword v16, v3, s[8:11], s16 offen offset:0
    buffer_load_dword v17, v3, s[8:11], s16 offen offset:256
    buffer_load_dword v18, v3, s[8:11], s16 offen offset:512
    buffer_load_dword v19, v3, s[8:11], s16 offen offset:768
    buffer_load_dword v20, v3, s[8:11], s16 offen offset:1024
    buffer_load_dword v21, v3, s[8:11], s16 offen offset:1280
    buffer_load_dword v22, v3, s[8:11], s16 offen offset:1536
    buffer_load_dword v23, v3, s[8:11], s16 offen offset:1792
    buffer_load_dword v24, v3, s[8:11], s16 offen offset:2048
    buffer_load_dword v25, v3, s[8:11], s16 offen offset:2304
    v_mul_u32_u24 v12, 40, v1
    v_lshlrev_b32 v13, 2, v2
    v_add_u32 v12, v12, v13
    s_waitcnt vmcnt(0)
    v_lshlrev_b32 v30, 16, v16
    v_and_b32 v31, 0xffff0000, v16
    v_lshlrev_b32 v32, 16, v17
    v_and_b32 v33, 0xffff0000, v17
    v_lshlrev_b32 v34, 16, v18
    v_and_b32 v35, 0xffff0000, v18
    v_lshlrev_b32 v36, 16, v19
    v_and_b32 v37, 0xffff0000, v19
    v_lshlrev_b32 v38, 16, v20
    v_and_b32 v39, 0xffff0000, v20
    v_lshlrev_b32 v40, 16, v21
    v_and_b32 v41, 0xffff0000, v21
    v_lshlrev_b32 v42, 16, v22
    v_and_b32 v43, 0xffff0000, v22
    v_lshlrev_b32 v44, 16, v23
    v_and_b32 v45, 0xffff0000, v23
    v_lshlrev_b32 v46, 16, v24
    v_and_b32 v47, 0xffff0000, v24
    v_lshlrev_b32 v48, 16, v25
    v_and_b32 v49, 0xffff0000, v25
    v_add_f32 v70, v30, v31
    v_add_f32 v75, v40, v41
    v_add_f32 v70, v70, v32
    v_add_f32 v75, v75, v42
    v_add_f32 v70, v70, v33
    v_add_f32 v75, v75, v43
    v_add_f32 v70, v70, v34
    v_add_f32 v75, v75, v44
    v_add_f32 v70, v70, v35
    v_add_f32 v75, v75, v45
    v_add_f32 v70, v70, v36
    v_add_f32 v75, v75, v46
    v_add_f32 v70, v70, v37
    v_add_f32 v75, v75, v47
    v_add_f32 v70, v70, v38
    v_add_f32 v75, v75, v48
    v_add_f32 v70, v70, v39
    v_add_f32 v75, v75, v49
    s_nop 0
    v_add_f32_dpp v70, v70, v70 quad_perm:[1,0,3,2] row_mask:0xf bank_mask:0xf
    v_add_f32_dpp v75, v75, v75 quad_perm:[1,0,3,2] row_mask:0xf bank_mask:0xf
    s_nop 0
    v_add_f32_dpp v70, v70, v70 quad_perm:[2,3,0,1] row_mask:0xf bank_mask:0xf
    v_add_f32_dpp v75, v75, v75 quad_perm:[2,3,0,1] row_mask:0xf bank_mask:0xf
    s_nop 0
    v_add_f32_dpp v70, v70, v70 row_half_mirror row_mask:0xf bank_mask:0xf
    v_add_f32_dpp v75, v75, v75 row_half_mirror row_mask:0xf bank_mask:0xf
    s_nop 0
    v_add_f32_dpp v70, v70, v70 row_mirror row_mask:0xf bank_mask:0xf
    v_add_f32_dpp v75, v75, v75 row_mirror row_mask:0xf bank_mask:0xf
    s_nop 0
    v_add_f32_dpp v70, v70, v70 row_bcast:15 row_mask:0xa bank_mask:0xf
    v_add_f32_dpp v75, v75, v75 row_bcast:15 row_mask:0xa bank_mask:0xf
    s_nop 0
    v_add_f32_dpp v70, v70, v70 row_bcast:31 row_mask:0xc bank_mask:0xf
    v_add_f32_dpp v75, v75, v75 row_bcast:31 row_mask:0xc bank_mask:0xf
    s_nop 0
    v_readlane_b32 s20, v70, 63
    v_readlane_b32 s21, v75, 63
    s_nop 1
    v_mov_b32 v71, s20
    v_mov_b32 v76, s21
    v_mul_f32 v71, 0x3acccccd, v71
    v_mul_f32 v76, 0x3acccccd, v76
    v_sub_f32 v72, v30, v71
    v_sub_f32 v77, v40, v76
    v_mul_f32 v70, v72, v72
    v_mul_f32 v75, v77, v77
    v_sub_f32 v72, v31, v71
    v_sub_f32 v77, v41, v76
    v_fmac_f32 v70, v72, v72
    v_fmac_f32 v75, v77, v77
    v_sub_f32 v72, v32, v71
    v_sub_f32 v77, v42, v76
    v_fmac_f32 v70, v72, v72
    v_fmac_f32 v75, v77, v77
    v_sub_f32 v72, v33, v71
    v_sub_f32 v77, v43, v76
    v_fmac_f32 v70, v72, v72
    v_fmac_f32 v75, v77, v77
    v_sub_f32 v72, v34, v71
    v_sub_f32 v77, v44, v76
    v_fmac_f32 v70, v72, v72
    v_fmac_f32 v75, v77, v77
    v_sub_f32 v72, v35, v71
    v_sub_f32 v77, v45, v76
    v_fmac_f32 v70, v72, v72
    v_fmac_f32 v75, v77, v77
    v_sub_f32 v72, v36, v71
    v_sub_f32 v77, v46, v76
    v_fmac_f32 v70, v72, v72
    v_fmac_f32 v75, v77, v77
    v_sub_f32 v72, v37, v71
    v_sub_f32 v77, v47, v76
    v_fmac_f32 v70, v72, v72
    v_fmac_f32 v75, v77, v77
    v_sub_f32 v72, v38, v71
    v_sub_f32 v77, v48, v76
    v_fmac_f32 v70, v72, v72
    v_fmac_f32 v75, v77, v77
    v_sub_f32 v72, v39, v71
    v_sub_f32 v77, v49, v76
    v_fmac_f32 v70, v72, v72
    v_fmac_f32 v75, v77, v77
    s_nop 0
    v_add_f32_dpp v70, v70, v70 quad_perm:[1,0,3,2] row_mask:0xf bank_mask:0xf
    v_add_f32_dpp v75, v75, v75 quad_perm:[1,0,3,2] row_mask:0xf bank_mask:0xf
    s_nop 0
    v_add_f32_dpp v70, v70, v70 quad_perm:[2,3,0,1] row_mask:0xf bank_mask:0xf
    v_add_f32_dpp v75, v75, v75 quad_perm:[2,3,0,1] row_mask:0xf bank_mask:0xf
    s_nop 0
    v_add_f32_dpp v70, v70, v70 row_half_mirror row_mask:0xf bank_mask:0xf
    v_add_f32_dpp v75, v75, v75 row_half_mirror row_mask:0xf bank_mask:0xf
    s_nop 0
    v_add_f32_dpp v70, v70, v70 row_mirror row_mask:0xf bank_mask:0xf
    v_add_f32_dpp v75, v75, v75 row_mirror row_mask:0xf bank_mask:0xf
    s_nop 0
    v_add_f32_dpp v70, v70, v70 row_bcast:15 row_mask:0xa bank_mask:0xf
    v_add_f32_dpp v75, v75, v75 row_bcast:15 row_mask:0xa bank_mask:0xf
    s_nop 0
    v_add_f32_dpp v70, v70, v70 row_bcast:31 row_mask:0xc bank_mask:0xf
    v_add_f32_dpp v75, v75, v75 row_bcast:31 row_mask:0xc bank_mask:0xf
    s_nop 0
    v_readlane_b32 s20, v70, 63
    v_readlane_b32 s21, v75, 63
    s_nop 1
    v_mov_b32 v72, s20
    v_mov_b32 v77, s21
    v_mul_f32 v72, 0x3acccccd, v72
    v_mul_f32 v77, 0x3acccccd, v77
    v_cvt_pk_bf16_f32 v73, v71, v71
    v_cvt_pk_bf16_f32 v78, v76, v76
    v_lshlrev_b32 v73, 16, v73
    v_lshlrev_b32 v78, 16, v78
    v_cvt_pk_bf16_f32 v74, v72, v72
    v_cvt_pk_bf16_f32 v79, v77, v77
    v_lshlrev_b32 v74, 16, v74
    v_lshlrev_b32 v79, 16, v79
    v_add_f32 v74, 0x3727c5ac, v74
    v_add_f32 v79, 0x3727c5ac, v79
    v_cvt_pk_bf16_f32 v74, v74, v74
    v_cvt_pk_bf16_f32 v79, v79, v79
    v_lshlrev_b32 v74, 16, v74
    v_lshlrev_b32 v79, 16, v79
    v_sqrt_f32 v74, v74
    v_sqrt_f32 v79, v79
    s_nop 0
    v_cvt_pk_bf16_f32 v74, v74, v74
    v_cvt_pk_bf16_f32 v79, v79, v79
    v_lshlrev_b32 v74, 16, v74
    v_lshlrev_b32 v79, 16, v79
    v_rcp_f32 v70, v74
    v_rcp_f32 v75, v79
    s_nop 0
    v_sub_f32 v50, v30, v73
    v_sub_f32 v60, v40, v78
    v_sub_f32 v51, v31, v73
    v_sub_f32 v61, v41, v78
    v_cvt_pk_bf16_f32 v72, v50, v51
    v_cvt_pk_bf16_f32 v77, v60, v61
    v_lshlrev_b32 v50, 16, v72
    v_lshlrev_b32 v60, 16, v77
    v_and_b32 v51, 0xffff0000, v72
    v_and_b32 v61, 0xffff0000, v77
    v_mul_f32 v72, v50, v70
    v_mul_f32 v77, v60, v75
    v_fma_f32 v50, -v72, v74, v50
    v_fma_f32 v60, -v77, v79, v60
    v_fma_f32 v50, v50, v70, v72
    v_fma_f32 v60, v60, v75, v77
    v_mul_f32 v72, v51, v70
    v_mul_f32 v77, v61, v75
    v_fma_f32 v51, -v72, v74, v51
    v_fma_f32 v61, -v77, v79, v61
    v_fma_f32 v51, v51, v70, v72
    v_fma_f32 v61, v61, v75, v77
    v_sub_f32 v52, v32, v73
    v_sub_f32 v62, v42, v78
    v_sub_f32 v53, v33, v73
    v_sub_f32 v63, v43, v78
    v_cvt_pk_bf16_f32 v72, v52, v53
    v_cvt_pk_bf16_f32 v77, v62, v63
    v_lshlrev_b32 v52, 16, v72
    v_lshlrev_b32 v62, 16, v77
    v_and_b32 v53, 0xffff0000, v72
    v_and_b32 v63, 0xffff0000, v77
    v_mul_f32 v72, v52, v70
    v_mul_f32 v77, v62, v75
    v_fma_f32 v52, -v72, v74, v52
    v_fma_f32 v62, -v77, v79, v62
    v_fma_f32 v52, v52, v70, v72
    v_fma_f32 v62, v62, v75, v77
    v_mul_f32 v72, v53, v70
    v_mul_f32 v77, v63, v75
    v_fma_f32 v53, -v72, v74, v53
    v_fma_f32 v63, -v77, v79, v63
    v_fma_f32 v53, v53, v70, v72
    v_fma_f32 v63, v63, v75, v77
    v_sub_f32 v54, v34, v73
    v_sub_f32 v64, v44, v78
    v_sub_f32 v55, v35, v73
    v_sub_f32 v65, v45, v78
    v_cvt_pk_bf16_f32 v72, v54, v55
    v_cvt_pk_bf16_f32 v77, v64, v65
    v_lshlrev_b32 v54, 16, v72
    v_lshlrev_b32 v64, 16, v77
    v_and_b32 v55, 0xffff0000, v72
    v_and_b32 v65, 0xffff0000, v77
    v_mul_f32 v72, v54, v70
    v_mul_f32 v77, v64, v75
    v_fma_f32 v54, -v72, v74, v54
    v_fma_f32 v64, -v77, v79, v64
    v_fma_f32 v54, v54, v70, v72
    v_fma_f32 v64, v64, v75, v77
    v_mul_f32 v72, v55, v70
    v_mul_f32 v77, v65, v75
    v_fma_f32 v55, -v72, v74, v55
    v_fma_f32 v65, -v77, v79, v65
    v_fma_f32 v55, v55, v70, v72
    v_fma_f32 v65, v65, v75, v77
    v_sub_f32 v56, v36, v73
    v_sub_f32 v66, v46, v78
    v_sub_f32 v57, v37, v73
    v_sub_f32 v67, v47, v78
    v_cvt_pk_bf16_f32 v72, v56, v57
    v_cvt_pk_bf16_f32 v77, v66, v67
    v_lshlrev_b32 v56, 16, v72
    v_lshlrev_b32 v66, 16, v77
    v_and_b32 v57, 0xffff0000, v72
    v_and_b32 v67, 0xffff0000, v77
    v_mul_f32 v72, v56, v70
    v_mul_f32 v77, v66, v75
    v_fma_f32 v56, -v72, v74, v56
    v_fma_f32 v66, -v77, v79, v66
    v_fma_f32 v56, v56, v70, v72
    v_fma_f32 v66, v66, v75, v77
    v_mul_f32 v72, v57, v70
    v_mul_f32 v77, v67, v75
    v_fma_f32 v57, -v72, v74, v57
    v_fma_f32 v67, -v77, v79, v67
    v_fma_f32 v57, v57, v70, v72
    v_fma_f32 v67, v67, v75, v77
    v_sub_f32 v58, v38, v73
    v_sub_f32 v68, v48, v78
    v_sub_f32 v59, v39, v73
    v_sub_f32 v69, v49, v78
    v_cvt_pk_bf16_f32 v72, v58, v59
    v_cvt_pk_bf16_f32 v77, v68, v69
    v_lshlrev_b32 v58, 16, v72
    v_lshlrev_b32 v68, 16, v77
    v_and_b32 v59, 0xffff0000, v72
    v_and_b32 v69, 0xffff0000, v77
    v_mul_f32 v72, v58, v70
    v_mul_f32 v77, v68, v75
    v_fma_f32 v58, -v72, v74, v58
    v_fma_f32 v68, -v77, v79, v68
    v_fma_f32 v58, v58, v70, v72
    v_fma_f32 v68, v68, v75, v77
    v_mul_f32 v72, v59, v70
    v_mul_f32 v77, v69, v75
    v_fma_f32 v59, -v72, v74, v59
    v_fma_f32 v69, -v77, v79, v69
    v_fma_f32 v59, v59, v70, v72
    v_fma_f32 v69, v69, v75, v77
    v_cvt_pk_bf16_f32 v70, v50, v60
    ds_write_b32 v12, v70 offset:0
    v_cvt_pk_bf16_f32 v70, v51, v61
    ds_write_b32 v12, v70 offset:20
    v_cvt_pk_bf16_f32 v70, v52, v62
    ds_write_b32 v12, v70 offset:2560
    v_cvt_pk_bf16_f32 v70, v53, v63
    ds_write_b32 v12, v70 offset:2580
    v_cvt_pk_bf16_f32 v70, v54, v64
    ds_write_b32 v12, v70 offset:5120
    v_cvt_pk_bf16_f32 v70, v55, v65
    ds_write_b32 v12, v70 offset:5140
    v_cvt_pk_bf16_f32 v70, v56, v66
    ds_write_b32 v12, v70 offset:7680
    v_cvt_pk_bf16_f32 v70, v57, v67
    ds_write_b32 v12, v70 offset:7700
    v_cvt_pk_bf16_f32 v70, v58, v68
    ds_write_b32 v12, v70 offset:10240
    v_cvt_pk_bf16_f32 v70, v59, v69
    ds_write_b32 v12, v70 offset:10260
    s_waitcnt lgkmcnt(0)
    s_barrier
    v_mul_u32_u24 v5, 20, v0
    v_lshlrev_b32 v7, 4, v0
    ds_read2_b32 v[16:17], v5 offset0:0 offset1:1
    ds_read2_b32 v[18:19], v5 offset0:2 offset1:3
    v_add_u32 v5, 5120, v5
    ds_read2_b32 v[20:21], v5 offset0:0 offset1:1
    ds_read2_b32 v[22:23], v5 offset0:2 offset1:3
    v_add_u32 v5, 5120, v5
    ds_read2_b32 v[24:25], v5 offset0:0 offset1:1
    ds_read2_b32 v[26:27], v5 offset0:2 offset1:3
    s_waitcnt lgkmcnt(0)
    buffer_store_dwordx4 v[16:19], v7, s[12:15], s16 offen offset:0
    v_add_u32 v7, 4096, v7
    buffer_store_dwordx4 v[20:23], v7, s[12:15], s16 offen
    v_add_u32 v7, 4096, v7
    v_cmp_gt_u32 vcc, 128, v0
    s_nop 1
    s_and_saveexec_b64 s[18:19], vcc
    buffer_store_dwordx4 v[24:27], v7, s[12:15], s16 offen
L_k0_end:
    s_endpgm
.globl kc_kgenconv_kernel
.p2align 8
.type kc_kgenconv_kernel,@function
kc_kgenconv_kernel:
    s_cmp_ge_u32 s2, 640
    s_cbranch_scc1 L_kc_end
    s_load_dwordx2 s[4:5], s[0:1], 8
    s_load_dwordx2 s[6:7], s[0:1], 16
    s_load_dwordx2 s[20:21], s[0:1], 24
    s_load_dwordx2 s[22:23], s[0:1], 32
    s_load_dwordx2 s[24:25], s[0:1], 40
    s_load_dwordx2 s[26:27], s[0:1], 112
    s_load_dwordx2 s[48:49], s[0:1], 48
    v_and_b32 v1, 63, v0
    v_lshrrev_b32 v2, 6, v0
    s_waitcnt lgkmcnt(0)
    s_mov_b32 s8, s4
    s_mov_b32 s9, s5
    s_mov_b32 s10, 245760
    s_mov_b32 s11, 0x00020000
    s_mov_b32 s12, s6
    s_mov_b32 s13, s7
    s_mov_b32 s14, 245760
    s_mov_b32 s15, 0x00020000
    s_mov_b32 s28, s20
    s_mov_b32 s29, s21
    s_mov_b32 s30, 245760
    s_mov_b32 s31, 0x00020000
    s_mov_b32 s32, s22
    s_mov_b32 s33, s23
    s_mov_b32 s34, 245760
    s_mov_b32 s35, 0x00020000
    s_mov_b32 s36, s24
    s_mov_b32 s37, s25
    s_mov_b32 s38, 1280
    s_mov_b32 s39, 0x00020000
    s_mov_b32 s40, s26
    s_mov_b32 s41, s27
    s_mov_b32 s42, 2621440
    s_mov_b32 s43, 0x00020000
    s_add_u32 s52, s26, 2621440
    s_addc_u32 s53, s27, 0
    s_mov_b32 s54, 2621440
    s_mov_b32 s55, 0x00020000
    s_mov_b32 s56, s48
    s_mov_b32 s57, s49
    s_mov_b32 s58, 1280
    s_mov_b32 s59, 0x00020000
    v_mul_u32_u24 v3, 48, v2
    v_add_u32 v3, v3, v1
    s_mul_i32 s16, s2, 384
    v_lshlrev_b32 v4, 1, v3
    buffer_load_ushort v10, v4, s[8:11], s16 offen
    buffer_load_ushort v11, v4, s[12:15], s16 offen
    buffer_load_ushort v12, v4, s[28:31], s16 offen
    buffer_load_ushort v13, v4, s[32:35], s16 offen
    s_lshl_b32 s17, s2, 1
    v_mov_b32 v5, 0
    buffer_load_ushort v14, v5, s[36:39], s17 offen
    buffer_load_ushort v164, v5, s[56:59], s17 offen
    s_lshl_b32 s18, s2, 4
    v_mul_u32_u24 v165, 10240, v0
    buffer_load_dwordx4 v[160:163], v165, s[40:43], s18 offen
    s_waitcnt vmcnt(2)
    v_lshlrev_b32 v10, 16, v10
    v_lshlrev_b32 v11, 16, v11
    v_lshlrev_b32 v12, 16, v12
    v_lshlrev_b32 v13, 16, v13
    v_lshlrev_b32 v14, 16, v14
    v_mul_f32 v14, 0x3fb8aa3b, v14
    v_exp_f32 v14, v14
    v_mul_f32 v10, 0x3fb8aa3b, v10
    v_exp_f32 v10, v10
    s_nop 0
    v_cvt_pk_bf16_f32 v14, v14, v14
    v_lshlrev_b32 v14, 16, v14
    v_cvt_pk_bf16_f32 v10, v10, v10
    v_lshlrev_b32 v10, 16, v10
    v_mul_f32 v10, v10, v14
    v_mul_f32 v16, 0xbfb8aa3b, v10
    v_mul_f32 v11, v11, v14
    v_mul_f32 v17, 0x3e22f983, v11
    v_mul_f32 v18, v12, v14
    v_add_f32 v18, v18, v18
    v_mul_f32 v19, v13, v14
    v_add_f32 v19, v19, v19
    v_mul_f32 v20, 0x45000000, v16
    v_exp_f32 v20, v20
    v_mul_f32 v21, 0x45000000, v17
    v_fract_f32 v21, v21
    v_sin_f32 v22, v21
    v_cos_f32 v23, v21
    s_nop 0
    v_mul_f32 v24, v18, v23
    v_fma_f32 v24, -v19, v22, v24
    v_mul_f32 v24, v24, v20
    v_mul_f32 v20, 0x44800000, v16
    v_exp_f32 v20, v20
    v_mul_f32 v21, 0x44800000, v17
    v_fract_f32 v21, v21
    v_sin_f32 v27, v21
    v_cos_f32 v26, v21
    s_nop 0
    v_mul_f32 v26, v26, v20
    v_mul_f32 v27, v27, v20
    v_cmp_gt_u32 vcc, 48, v1
    s_nop 1
    v_cndmask_b32 v24, 0, v24, vcc
    s_and_saveexec_b64 s[44:45], vcc
    v_lshlrev_b32 v5, 5, v3
    ds_write_b128 v5, v[16:19] offset:36864
    ds_write_b64 v5, v[26:27] offset:36880
    s_mov_b64 exec, s[44:45]
    s_nop 1
    v_add_f32_dpp v24, v24, v24 quad_perm:[1,0,3,2] row_mask:0xf bank_mask:0xf
    s_nop 1
    v_add_f32_dpp v24, v24, v24 quad_perm:[2,3,0,1] row_mask:0xf bank_mask:0xf
    s_nop 1
    v_add_f32_dpp v24, v24, v24 row_half_mirror row_mask:0xf bank_mask:0xf
    s_nop 1
    v_add_f32_dpp v24, v24, v24 row_mirror row_mask:0xf bank_mask:0xf
    s_nop 1
    v_add_f32_dpp v24, v24, v24 row_bcast:15 row_mask:0xa bank_mask:0xf
    s_nop 1
    v_add_f32_dpp v24, v24, v24 row_bcast:31 row_mask:0xc bank_mask:0xf
    s_nop 0
    v_readlane_b32 s46, v24, 63
    s_nop 1
    s_waitcnt lgkmcnt(0)
    s_barrier
    v_and_b32 v4, 31, v1
    v_lshrrev_b32 v5, 5, v1
    v_cvt_f32_u32 v6, v4
    v_lshlrev_b32 v7, 5, v4
    v_cvt_f32_u32 v7, v7
    v_add_f32 v8, 0x44800000, v7
    v_mul_u32_u24 v9, 48, v2
    v_lshlrev_b32 v10, 2, v5
    v_add_u32 v9, v9, v10
    v_lshlrev_b32 v9, 5, v9
    v_mov_b32 v128, 0
    v_mov_b32 v129, 0
    v_mov_b32 v130, 0
    v_mov_b32 v131, 0
    v_mov_b32 v132, 0
    v_mov_b32 v133, 0
    v_mov_b32 v134, 0
    v_mov_b32 v135, 0
    v_mov_b32 v136, 0
    v_mov_b32 v137, 0
    v_mov_b32 v138, 0
    v_mov_b32 v139, 0
    v_mov_b32 v140, 0
    v_mov_b32 v141, 0
    v_mov_b32 v142, 0
    v_mov_b32 v143, 0
    v_mov_b32 v144, 0
    v_mov_b32 v145, 0
    v_mov_b32 v146, 0
    v_mov_b32 v147, 0
    v_mov_b32 v148, 0
    v_mov_b32 v149, 0
    v_mov_b32 v150, 0
    v_mov_b32 v151, 0
    v_mov_b32 v152, 0
    v_mov_b32 v153, 0
    v_mov_b32 v154, 0
    v_mov_b32 v155, 0
    v_mov_b32 v156, 0
    v_mov_b32 v157, 0
    v_mov_b32 v158, 0
    v_mov_b32 v159, 0
    ds_read_b128 v[32:35], v9 offset:36864
    ds_read_b64 v[36:37], v9 offset:36880
    ds_read_b128 v[40:43], v9 offset:36896
    ds_read_b64 v[44:45], v9 offset:36912
    ds_read_b128 v[112:115], v9 offset:36928
    ds_read_b64 v[116:117], v9 offset:36944
    ds_read_b128 v[120:123], v9 offset:36960
    ds_read_b64 v[124:125], v9 offset:36976
    s_waitcnt lgkmcnt(0)
    v_mul_f32 v80, v32, v6
    v_mul_f32 v88, v40, v6
    v_mul_f32 v96, v112, v6
    v_mul_f32 v104, v120, v6
    v_mul_f32 v81, v33, v6
    v_mul_f32 v89, v41, v6
    v_mul_f32 v97, v113, v6
    v_mul_f32 v105, v121, v6
    v_exp_f32 v80, v80
    v_exp_f32 v88, v88
    v_exp_f32 v96, v96
    v_exp_f32 v104, v104
    v_fract_f32 v81, v81
    v_fract_f32 v89, v89
    v_fract_f32 v97, v97
    v_fract_f32 v105, v105
    v_sin_f32 v82, v81
    v_sin_f32 v90, v89
    v_sin_f32 v98, v97
    v_sin_f32 v106, v105
    v_cos_f32 v83, v81
    v_cos_f32 v91, v89
    v_cos_f32 v99, v97
    v_cos_f32 v107, v105
    v_mul_f32 v84, v34, v83
    v_mul_f32 v92, v42, v91
    v_mul_f32 v100, v114, v99
    v_mul_f32 v108, v122, v107
    v_mul_f32 v85, v34, v82
    v_mul_f32 v93, v42, v90
    v_mul_f32 v101, v114, v98
    v_mul_f32 v109, v122, v106
    v_fma_f32 v84, -v35, v82, v84
    v_fma_f32 v92, -v43, v90, v92
    v_fma_f32 v100, -v115, v98, v100
    v_fma_f32 v108, -v123, v106, v108
    v_fma_f32 v85, v35, v83, v85
    v_fma_f32 v93, v43, v91, v93
    v_fma_f32 v101, v115, v99, v101
    v_fma_f32 v109, v123, v107, v109
    v_mul_f32 v84, v84, v80
    v_mul_f32 v92, v92, v88
    v_mul_f32 v100, v100, v96
    v_mul_f32 v108, v108, v104
    v_mul_f32 v85, -v85, v80
    v_mul_f32 v93, -v93, v88
    v_mul_f32 v101, -v101, v96
    v_mul_f32 v109, -v109, v104
    v_cvt_pk_bf16_f32 v48, v84, v85
    v_cvt_pk_bf16_f32 v49, v92, v93
    v_cvt_pk_bf16_f32 v50, v100, v101
    v_cvt_pk_bf16_f32 v51, v108, v109
    v_lshlrev_b32 v86, 16, v48
    v_lshlrev_b32 v94, 16, v49
    v_lshlrev_b32 v102, 16, v50
    v_lshlrev_b32 v110, 16, v51
    v_and_b32 v87, 0xffff0000, v48
    v_and_b32 v95, 0xffff0000, v49
    v_and_b32 v103, 0xffff0000, v50
    v_and_b32 v111, 0xffff0000, v51
    v_sub_f32 v86, v84, v86
    v_sub_f32 v94, v92, v94
    v_sub_f32 v102, v100, v102
    v_sub_f32 v110, v108, v110
    v_sub_f32 v87, v85, v87
    v_sub_f32 v95, v93, v95
    v_sub_f32 v103, v101, v103
    v_sub_f32 v111, v109, v111
    v_cvt_pk_bf16_f32 v52, v86, v87
    v_cvt_pk_bf16_f32 v53, v94, v95
    v_cvt_pk_bf16_f32 v54, v102, v103
    v_cvt_pk_bf16_f32 v55, v110, v111
    v_mul_f32 v80, v32, v7
    v_mul_f32 v88, v40, v7
    v_mul_f32 v96, v112, v7
    v_mul_f32 v104, v120, v7
    v_mul_f32 v81, v33, v7
    v_mul_f32 v89, v41, v7
    v_mul_f32 v97, v113, v7
    v_mul_f32 v105, v121, v7
    v_exp_f32 v80, v80
    v_exp_f32 v88, v88
    v_exp_f32 v96, v96
    v_exp_f32 v104, v104
    v_fract_f32 v81, v81
    v_fract_f32 v89, v89
    v_fract_f32 v97, v97
    v_fract_f32 v105, v105
    v_sin_f32 v82, v81
    v_sin_f32 v90, v89
    v_sin_f32 v98, v97
    v_sin_f32 v106, v105
    v_cos_f32 v83, v81
    v_cos_f32 v91, v89
    v_cos_f32 v99, v97
    v_cos_f32 v107, v105
    v_mul_f32 v84, v83, v80
    v_mul_f32 v92, v91, v88
    v_mul_f32 v100, v99, v96
    v_mul_f32 v108, v107, v104
    v_mul_f32 v85, v82, v80
    v_mul_f32 v93, v90, v88
    v_mul_f32 v101, v98, v96
    v_mul_f32 v109, v106, v104
    v_cvt_pk_bf16_f32 v56, v84, v85
    v_cvt_pk_bf16_f32 v57, v92, v93
    v_cvt_pk_bf16_f32 v58, v100, v101
    v_cvt_pk_bf16_f32 v59, v108, v109
    v_lshlrev_b32 v86, 16, v56
    v_lshlrev_b32 v94, 16, v57
    v_lshlrev_b32 v102, 16, v58
    v_lshlrev_b32 v110, 16, v59
    v_and_b32 v87, 0xffff0000, v56
    v_and_b32 v95, 0xffff0000, v57
    v_and_b32 v103, 0xffff0000, v58
    v_and_b32 v111, 0xffff0000, v59
    v_sub_f32 v86, v84, v86
    v_sub_f32 v94, v92, v94
    v_sub_f32 v102, v100, v102
    v_sub_f32 v110, v108, v110
    v_sub_f32 v87, v85, v87
    v_sub_f32 v95, v93, v95
    v_sub_f32 v103, v101, v103
    v_sub_f32 v111, v109, v111
    v_cvt_pk_bf16_f32 v60, v86, v87
    v_cvt_pk_bf16_f32 v61, v94, v95
    v_cvt_pk_bf16_f32 v62, v102, v103
    v_cvt_pk_bf16_f32 v63, v110, v111
    v_mul_f32 v82, v84, v36
    v_mul_f32 v90, v92, v44
    v_mul_f32 v98, v100, v116
    v_mul_f32 v106, v108, v124
    v_mul_f32 v83, v84, v37
    v_mul_f32 v91, v92, v45
    v_mul_f32 v99, v100, v117
    v_mul_f32 v107, v108, v125
    v_fma_f32 v82, -v85, v37, v82
    v_fma_f32 v90, -v93, v45, v90
    v_fma_f32 v98, -v101, v117, v98
    v_fma_f32 v106, -v109, v125, v106
    v_fma_f32 v83, v85, v36, v83
    v_fma_f32 v91, v93, v44, v91
    v_fma_f32 v99, v101, v116, v99
    v_fma_f32 v107, v109, v124, v107
    v_mov_b32 v84, v82
    v_mov_b32 v92, v90
    v_mov_b32 v100, v98
    v_mov_b32 v108, v106
    v_mov_b32 v85, v83
    v_mov_b32 v93, v91
    v_mov_b32 v101, v99
    v_mov_b32 v109, v107
    v_cvt_pk_bf16_f32 v64, v84, v85
    v_cvt_pk_bf16_f32 v65, v92, v93
    v_cvt_pk_bf16_f32 v66, v100, v101
    v_cvt_pk_bf16_f32 v67, v108, v109
    v_lshlrev_b32 v86, 16, v64
    v_lshlrev_b32 v94, 16, v65
    v_lshlrev_b32 v102, 16, v66
    v_lshlrev_b32 v110, 16, v67
    v_and_b32 v87, 0xffff0000, v64
    v_and_b32 v95, 0xffff0000, v65
    v_and_b32 v103, 0xffff0000, v66
    v_and_b32 v111, 0xffff0000, v67
    v_sub_f32 v86, v84, v86
    v_sub_f32 v94, v92, v94
    v_sub_f32 v102, v100, v102
    v_sub_f32 v110, v108, v110
    v_sub_f32 v87, v85, v87
    v_sub_f32 v95, v93, v95
    v_sub_f32 v103, v101, v103
    v_sub_f32 v111, v109, v111
    v_cvt_pk_bf16_f32 v68, v86, v87
    v_cvt_pk_bf16_f32 v69, v94, v95
    v_cvt_pk_bf16_f32 v70, v102, v103
    v_cvt_pk_bf16_f32 v71, v110, v111
    s_nop 1
    v_mfma_f32_32x32x16_bf16 v[128:143], v[56:59], v[48:51], v[128:143]
    v_mfma_f32_32x32x16_bf16 v[128:143], v[56:59], v[52:55], v[128:143]
    v_mfma_f32_32x32x16_bf16 v[128:143], v[60:63], v[48:51], v[128:143]
    v_mfma_f32_32x32x16_bf16 v[144:159], v[64:67], v[48:51], v[144:159]
    v_mfma_f32_32x32x16_bf16 v[144:159], v[64:67], v[52:55], v[144:159]
    v_mfma_f32_32x32x16_bf16 v[144:159], v[68:71], v[48:51], v[144:159]
    ds_read_b128 v[32:35], v9 offset:37120
    ds_read_b64 v[36:37], v9 offset:37136
    ds_read_b128 v[40:43], v9 offset:37152
    ds_read_b64 v[44:45], v9 offset:37168
    ds_read_b128 v[112:115], v9 offset:37184
    ds_read_b64 v[116:117], v9 offset:37200
    ds_read_b128 v[120:123], v9 offset:37216
    ds_read_b64 v[124:125], v9 offset:37232
    s_waitcnt lgkmcnt(0)
    v_mul_f32 v80, v32, v6
    v_mul_f32 v88, v40, v6
    v_mul_f32 v96, v112, v6
    v_mul_f32 v104, v120, v6
    v_mul_f32 v81, v33, v6
    v_mul_f32 v89, v41, v6
    v_mul_f32 v97, v113, v6
    v_mul_f32 v105, v121, v6
    v_exp_f32 v80, v80
    v_exp_f32 v88, v88
    v_exp_f32 v96, v96
    v_exp_f32 v104, v104
    v_fract_f32 v81, v81
    v_fract_f32 v89, v89
    v_fract_f32 v97, v97
    v_fract_f32 v105, v105
    v_sin_f32 v82, v81
    v_sin_f32 v90, v89
    v_sin_f32 v98, v97
    v_sin_f32 v106, v105
    v_cos_f32 v83, v81
    v_cos_f32 v91, v89
    v_cos_f32 v99, v97
    v_cos_f32 v107, v105
    v_mul_f32 v84, v34, v83
    v_mul_f32 v92, v42, v91
    v_mul_f32 v100, v114, v99
    v_mul_f32 v108, v122, v107
    v_mul_f32 v85, v34, v82
    v_mul_f32 v93, v42, v90
    v_mul_f32 v101, v114, v98
    v_mul_f32 v109, v122, v106
    v_fma_f32 v84, -v35, v82, v84
    v_fma_f32 v92, -v43, v90, v92
    v_fma_f32 v100, -v115, v98, v100
    v_fma_f32 v108, -v123, v106, v108
    v_fma_f32 v85, v35, v83, v85
    v_fma_f32 v93, v43, v91, v93
    v_fma_f32 v101, v115, v99, v101
    v_fma_f32 v109, v123, v107, v109
    v_mul_f32 v84, v84, v80
    v_mul_f32 v92, v92, v88
    v_mul_f32 v100, v100, v96
    v_mul_f32 v108, v108, v104
    v_mul_f32 v85, -v85, v80
    v_mul_f32 v93, -v93, v88
    v_mul_f32 v101, -v101, v96
    v_mul_f32 v109, -v109, v104
    v_cvt_pk_bf16_f32 v48, v84, v85
    v_cvt_pk_bf16_f32 v49, v92, v93
    v_cvt_pk_bf16_f32 v50, v100, v101
    v_cvt_pk_bf16_f32 v51, v108, v109
    v_lshlrev_b32 v86, 16, v48
    v_lshlrev_b32 v94, 16, v49
    v_lshlrev_b32 v102, 16, v50
    v_lshlrev_b32 v110, 16, v51
    v_and_b32 v87, 0xffff0000, v48
    v_and_b32 v95, 0xffff0000, v49
    v_and_b32 v103, 0xffff0000, v50
    v_and_b32 v111, 0xffff0000, v51
    v_sub_f32 v86, v84, v86
    v_sub_f32 v94, v92, v94
    v_sub_f32 v102, v100, v102
    v_sub_f32 v110, v108, v110
    v_sub_f32 v87, v85, v87
    v_sub_f32 v95, v93, v95
    v_sub_f32 v103, v101, v103
    v_sub_f32 v111, v109, v111
    v_cvt_pk_bf16_f32 v52, v86, v87
    v_cvt_pk_bf16_f32 v53, v94, v95
    v_cvt_pk_bf16_f32 v54, v102, v103
    v_cvt_pk_bf16_f32 v55, v110, v111
    v_mul_f32 v80, v32, v7
    v_mul_f32 v88, v40, v7
    v_mul_f32 v96, v112, v7
    v_mul_f32 v104, v120, v7
    v_mul_f32 v81, v33, v7
    v_mul_f32 v89, v41, v7
    v_mul_f32 v97, v113, v7
    v_mul_f32 v105, v121, v7
    v_exp_f32 v80, v80
    v_exp_f32 v88, v88
    v_exp_f32 v96, v96
    v_exp_f32 v104, v104
    v_fract_f32 v81, v81
    v_fract_f32 v89, v89
    v_fract_f32 v97, v97
    v_fract_f32 v105, v105
    v_sin_f32 v82, v81
    v_sin_f32 v90, v89
    v_sin_f32 v98, v97
    v_sin_f32 v106, v105
    v_cos_f32 v83, v81
    v_cos_f32 v91, v89
    v_cos_f32 v99, v97
    v_cos_f32 v107, v105
    v_mul_f32 v84, v83, v80
    v_mul_f32 v92, v91, v88
    v_mul_f32 v100, v99, v96
    v_mul_f32 v108, v107, v104
    v_mul_f32 v85, v82, v80
    v_mul_f32 v93, v90, v88
    v_mul_f32 v101, v98, v96
    v_mul_f32 v109, v106, v104
    v_cvt_pk_bf16_f32 v56, v84, v85
    v_cvt_pk_bf16_f32 v57, v92, v93
    v_cvt_pk_bf16_f32 v58, v100, v101
    v_cvt_pk_bf16_f32 v59, v108, v109
    v_lshlrev_b32 v86, 16, v56
    v_lshlrev_b32 v94, 16, v57
    v_lshlrev_b32 v102, 16, v58
    v_lshlrev_b32 v110, 16, v59
    v_and_b32 v87, 0xffff0000, v56
    v_and_b32 v95, 0xffff0000, v57
    v_and_b32 v103, 0xffff0000, v58
    v_and_b32 v111, 0xffff0000, v59
    v_sub_f32 v86, v84, v86
    v_sub_f32 v94, v92, v94
    v_sub_f32 v102, v100, v102
    v_sub_f32 v110, v108, v110
    v_sub_f32 v87, v85, v87
    v_sub_f32 v95, v93, v95
    v_sub_f32 v103, v101, v103
    v_sub_f32 v111, v109, v111
    v_cvt_pk_bf16_f32 v60, v86, v87
    v_cvt_pk_bf16_f32 v61, v94, v95
    v_cvt_pk_bf16_f32 v62, v102, v103
    v_cvt_pk_bf16_f32 v63, v110, v111
    v_mul_f32 v82, v84, v36
    v_mul_f32 v90, v92, v44
    v_mul_f32 v98, v100, v116
    v_mul_f32 v106, v108, v124
    v_mul_f32 v83, v84, v37
    v_mul_f32 v91, v92, v45
    v_mul_f32 v99, v100, v117
    v_mul_f32 v107, v108, v125
    v_fma_f32 v82, -v85, v37, v82
    v_fma_f32 v90, -v93, v45, v90
    v_fma_f32 v98, -v101, v117, v98
    v_fma_f32 v106, -v109, v125, v106
    v_fma_f32 v83, v85, v36, v83
    v_fma_f32 v91, v93, v44, v91
    v_fma_f32 v99, v101, v116, v99
    v_fma_f32 v107, v109, v124, v107
    v_mov_b32 v84, v82
    v_mov_b32 v92, v90
    v_mov_b32 v100, v98
    v_mov_b32 v108, v106
    v_mov_b32 v85, v83
    v_mov_b32 v93, v91
    v_mov_b32 v101, v99
    v_mov_b32 v109, v107
    v_cvt_pk_bf16_f32 v64, v84, v85
    v_cvt_pk_bf16_f32 v65, v92, v93
    v_cvt_pk_bf16_f32 v66, v100, v101
    v_cvt_pk_bf16_f32 v67, v108, v109
    v_lshlrev_b32 v86, 16, v64
    v_lshlrev_b32 v94, 16, v65
    v_lshlrev_b32 v102, 16, v66
    v_lshlrev_b32 v110, 16, v67
    v_and_b32 v87, 0xffff0000, v64
    v_and_b32 v95, 0xffff0000, v65
    v_and_b32 v103, 0xffff0000, v66
    v_and_b32 v111, 0xffff0000, v67
    v_sub_f32 v86, v84, v86
    v_sub_f32 v94, v92, v94
    v_sub_f32 v102, v100, v102
    v_sub_f32 v110, v108, v110
    v_sub_f32 v87, v85, v87
    v_sub_f32 v95, v93, v95
    v_sub_f32 v103, v101, v103
    v_sub_f32 v111, v109, v111
    v_cvt_pk_bf16_f32 v68, v86, v87
    v_cvt_pk_bf16_f32 v69, v94, v95
    v_cvt_pk_bf16_f32 v70, v102, v103
    v_cvt_pk_bf16_f32 v71, v110, v111
    s_nop 1
    v_mfma_f32_32x32x16_bf16 v[128:143], v[56:59], v[48:51], v[128:143]
    v_mfma_f32_32x32x16_bf16 v[128:143], v[56:59], v[52:55], v[128:143]
    v_mfma_f32_32x32x16_bf16 v[128:143], v[60:63], v[48:51], v[128:143]
    v_mfma_f32_32x32x16_bf16 v[144:159], v[64:67], v[48:51], v[144:159]
    v_mfma_f32_32x32x16_bf16 v[144:159], v[64:67], v[52:55], v[144:159]
    v_mfma_f32_32x32x16_bf16 v[144:159], v[68:71], v[48:51], v[144:159]
    ds_read_b128 v[32:35], v9 offset:37376
    ds_read_b64 v[36:37], v9 offset:37392
    ds_read_b128 v[40:43], v9 offset:37408
    ds_read_b64 v[44:45], v9 offset:37424
    ds_read_b128 v[112:115], v9 offset:37440
    ds_read_b64 v[116:117], v9 offset:37456
    ds_read_b128 v[120:123], v9 offset:37472
    ds_read_b64 v[124:125], v9 offset:37488
    s_waitcnt lgkmcnt(0)
    v_mul_f32 v80, v32, v6
    v_mul_f32 v88, v40, v6
    v_mul_f32 v96, v112, v6
    v_mul_f32 v104, v120, v6
    v_mul_f32 v81, v33, v6
    v_mul_f32 v89, v41, v6
    v_mul_f32 v97, v113, v6
    v_mul_f32 v105, v121, v6
    v_exp_f32 v80, v80
    v_exp_f32 v88, v88
    v_exp_f32 v96, v96
    v_exp_f32 v104, v104
    v_fract_f32 v81, v81
    v_fract_f32 v89, v89
    v_fract_f32 v97, v97
    v_fract_f32 v105, v105
    v_sin_f32 v82, v81
    v_sin_f32 v90, v89
    v_sin_f32 v98, v97
    v_sin_f32 v106, v105
    v_cos_f32 v83, v81
    v_cos_f32 v91, v89
    v_cos_f32 v99, v97
    v_cos_f32 v107, v105
    v_mul_f32 v84, v34, v83
    v_mul_f32 v92, v42, v91
    v_mul_f32 v100, v114, v99
    v_mul_f32 v108, v122, v107
    v_mul_f32 v85, v34, v82
    v_mul_f32 v93, v42, v90
    v_mul_f32 v101, v114, v98
    v_mul_f32 v109, v122, v106
    v_fma_f32 v84, -v35, v82, v84
    v_fma_f32 v92, -v43, v90, v92
    v_fma_f32 v100, -v115, v98, v100
    v_fma_f32 v108, -v123, v106, v108
    v_fma_f32 v85, v35, v83, v85
    v_fma_f32 v93, v43, v91, v93
    v_fma_f32 v101, v115, v99, v101
    v_fma_f32 v109, v123, v107, v109
    v_mul_f32 v84, v84, v80
    v_mul_f32 v92, v92, v88
    v_mul_f32 v100, v100, v96
    v_mul_f32 v108, v108, v104
    v_mul_f32 v85, -v85, v80
    v_mul_f32 v93, -v93, v88
    v_mul_f32 v101, -v101, v96
    v_mul_f32 v109, -v109, v104
    v_cvt_pk_bf16_f32 v48, v84, v85
    v_cvt_pk_bf16_f32 v49, v92, v93
    v_cvt_pk_bf16_f32 v50, v100, v101
    v_cvt_pk_bf16_f32 v51, v108, v109
    v_lshlrev_b32 v86, 16, v48
    v_lshlrev_b32 v94, 16, v49
    v_lshlrev_b32 v102, 16, v50
    v_lshlrev_b32 v110, 16, v51
    v_and_b32 v87, 0xffff0000, v48
    v_and_b32 v95, 0xffff0000, v49
    v_and_b32 v103, 0xffff0000, v50
    v_and_b32 v111, 0xffff0000, v51
    v_sub_f32 v86, v84, v86
    v_sub_f32 v94, v92, v94
    v_sub_f32 v102, v100, v102
    v_sub_f32 v110, v108, v110
    v_sub_f32 v87, v85, v87
    v_sub_f32 v95, v93, v95
    v_sub_f32 v103, v101, v103
    v_sub_f32 v111, v109, v111
    v_cvt_pk_bf16_f32 v52, v86, v87
    v_cvt_pk_bf16_f32 v53, v94, v95
    v_cvt_pk_bf16_f32 v54, v102, v103
    v_cvt_pk_bf16_f32 v55, v110, v111
    v_mul_f32 v80, v32, v7
    v_mul_f32 v88, v40, v7
    v_mul_f32 v96, v112, v7
    v_mul_f32 v104, v120, v7
    v_mul_f32 v81, v33, v7
    v_mul_f32 v89, v41, v7
    v_mul_f32 v97, v113, v7
    v_mul_f32 v105, v121, v7
    v_exp_f32 v80, v80
    v_exp_f32 v88, v88
    v_exp_f32 v96, v96
    v_exp_f32 v104, v104
    v_fract_f32 v81, v81
    v_fract_f32 v89, v89
    v_fract_f32 v97, v97
    v_fract_f32 v105, v105
    v_sin_f32 v82, v81
    v_sin_f32 v90, v89
    v_sin_f32 v98, v97
    v_sin_f32 v106, v105
    v_cos_f32 v83, v81
    v_cos_f32 v91, v89
    v_cos_f32 v99, v97
    v_cos_f32 v107, v105
    v_mul_f32 v84, v83, v80
    v_mul_f32 v92, v91, v88
    v_mul_f32 v100, v99, v96
    v_mul_f32 v108, v107, v104
    v_mul_f32 v85, v82, v80
    v_mul_f32 v93, v90, v88
    v_mul_f32 v101, v98, v96
    v_mul_f32 v109, v106, v104
    v_cvt_pk_bf16_f32 v56, v84, v85
    v_cvt_pk_bf16_f32 v57, v92, v93
    v_cvt_pk_bf16_f32 v58, v100, v101
    v_cvt_pk_bf16_f32 v59, v108, v109
    v_lshlrev_b32 v86, 16, v56
    v_lshlrev_b32 v94, 16, v57
    v_lshlrev_b32 v102, 16, v58
    v_lshlrev_b32 v110, 16, v59
    v_and_b32 v87, 0xffff0000, v56
    v_and_b32 v95, 0xffff0000, v57
    v_and_b32 v103, 0xffff0000, v58
    v_and_b32 v111, 0xffff0000, v59
    v_sub_f32 v86, v84, v86
    v_sub_f32 v94, v92, v94
    v_sub_f32 v102, v100, v102
    v_sub_f32 v110, v108, v110
    v_sub_f32 v87, v85, v87
    v_sub_f32 v95, v93, v95
    v_sub_f32 v103, v101, v103
    v_sub_f32 v111, v109, v111
    v_cvt_pk_bf16_f32 v60, v86, v87
    v_cvt_pk_bf16_f32 v61, v94, v95
    v_cvt_pk_bf16_f32 v62, v102, v103
    v_cvt_pk_bf16_f32 v63, v110, v111
    v_mul_f32 v82, v84, v36
    v_mul_f32 v90, v92, v44
    v_mul_f32 v98, v100, v116
    v_mul_f32 v106, v108, v124
    v_mul_f32 v83, v84, v37
    v_mul_f32 v91, v92, v45
    v_mul_f32 v99, v100, v117
    v_mul_f32 v107, v108, v125
    v_fma_f32 v82, -v85, v37, v82
    v_fma_f32 v90, -v93, v45, v90
    v_fma_f32 v98, -v101, v117, v98
    v_fma_f32 v106, -v109, v125, v106
    v_fma_f32 v83, v85, v36, v83
    v_fma_f32 v91, v93, v44, v91
    v_fma_f32 v99, v101, v116, v99
    v_fma_f32 v107, v109, v124, v107
    v_mov_b32 v84, v82
    v_mov_b32 v92, v90
    v_mov_b32 v100, v98
    v_mov_b32 v108, v106
    v_mov_b32 v85, v83
    v_mov_b32 v93, v91
    v_mov_b32 v101, v99
    v_mov_b32 v109, v107
    v_cvt_pk_bf16_f32 v64, v84, v85
    v_cvt_pk_bf16_f32 v65, v92, v93
    v_cvt_pk_bf16_f32 v66, v100, v101
    v_cvt_pk_bf16_f32 v67, v108, v109
    v_lshlrev_b32 v86, 16, v64
    v_lshlrev_b32 v94, 16, v65
    v_lshlrev_b32 v102, 16, v66
    v_lshlrev_b32 v110, 16, v67
    v_and_b32 v87, 0xffff0000, v64
    v_and_b32 v95, 0xffff0000, v65
    v_and_b32 v103, 0xffff0000, v66
    v_and_b32 v111, 0xffff0000, v67
    v_sub_f32 v86, v84, v86
    v_sub_f32 v94, v92, v94
    v_sub_f32 v102, v100, v102
    v_sub_f32 v110, v108, v110
    v_sub_f32 v87, v85, v87
    v_sub_f32 v95, v93, v95
    v_sub_f32 v103, v101, v103
    v_sub_f32 v111, v109, v111
    v_cvt_pk_bf16_f32 v68, v86, v87
    v_cvt_pk_bf16_f32 v69, v94, v95
    v_cvt_pk_bf16_f32 v70, v102, v103
    v_cvt_pk_bf16_f32 v71, v110, v111
    s_nop 1
    v_mfma_f32_32x32x16_bf16 v[128:143], v[56:59], v[48:51], v[128:143]
    v_mfma_f32_32x32x16_bf16 v[128:143], v[56:59], v[52:55], v[128:143]
    v_mfma_f32_32x32x16_bf16 v[128:143], v[60:63], v[48:51], v[128:143]
    v_mfma_f32_32x32x16_bf16 v[144:159], v[64:67], v[48:51], v[144:159]
    v_mfma_f32_32x32x16_bf16 v[144:159], v[64:67], v[52:55], v[144:159]
    v_mfma_f32_32x32x16_bf16 v[144:159], v[68:71], v[48:51], v[144:159]
    ds_read_b128 v[32:35], v9 offset:37632
    ds_read_b64 v[36:37], v9 offset:37648
    ds_read_b128 v[40:43], v9 offset:37664
    ds_read_b64 v[44:45], v9 offset:37680
    ds_read_b128 v[112:115], v9 offset:37696
    ds_read_b64 v[116:117], v9 offset:37712
    ds_read_b128 v[120:123], v9 offset:37728
    ds_read_b64 v[124:125], v9 offset:37744
    s_waitcnt lgkmcnt(0)
    v_mul_f32 v80, v32, v6
    v_mul_f32 v88, v40, v6
    v_mul_f32 v96, v112, v6
    v_mul_f32 v104, v120, v6
    v_mul_f32 v81, v33, v6
    v_mul_f32 v89, v41, v6
    v_mul_f32 v97, v113, v6
    v_mul_f32 v105, v121, v6
    v_exp_f32 v80, v80
    v_exp_f32 v88, v88
    v_exp_f32 v96, v96
    v_exp_f32 v104, v104
    v_fract_f32 v81, v81
    v_fract_f32 v89, v89
    v_fract_f32 v97, v97
    v_fract_f32 v105, v105
    v_sin_f32 v82, v81
    v_sin_f32 v90, v89
    v_sin_f32 v98, v97
    v_sin_f32 v106, v105
    v_cos_f32 v83, v81
    v_cos_f32 v91, v89
    v_cos_f32 v99, v97
    v_cos_f32 v107, v105
    v_mul_f32 v84, v34, v83
    v_mul_f32 v92, v42, v91
    v_mul_f32 v100, v114, v99
    v_mul_f32 v108, v122, v107
    v_mul_f32 v85, v34, v82
    v_mul_f32 v93, v42, v90
    v_mul_f32 v101, v114, v98
    v_mul_f32 v109, v122, v106
    v_fma_f32 v84, -v35, v82, v84
    v_fma_f32 v92, -v43, v90, v92
    v_fma_f32 v100, -v115, v98, v100
    v_fma_f32 v108, -v123, v106, v108
    v_fma_f32 v85, v35, v83, v85
    v_fma_f32 v93, v43, v91, v93
    v_fma_f32 v101, v115, v99, v101
    v_fma_f32 v109, v123, v107, v109
    v_mul_f32 v84, v84, v80
    v_mul_f32 v92, v92, v88
    v_mul_f32 v100, v100, v96
    v_mul_f32 v108, v108, v104
    v_mul_f32 v85, -v85, v80
    v_mul_f32 v93, -v93, v88
    v_mul_f32 v101, -v101, v96
    v_mul_f32 v109, -v109, v104
    v_cvt_pk_bf16_f32 v48, v84, v85
    v_cvt_pk_bf16_f32 v49, v92, v93
    v_cvt_pk_bf16_f32 v50, v100, v101
    v_cvt_pk_bf16_f32 v51, v108, v109
    v_lshlrev_b32 v86, 16, v48
    v_lshlrev_b32 v94, 16, v49
    v_lshlrev_b32 v102, 16, v50
    v_lshlrev_b32 v110, 16, v51
    v_and_b32 v87, 0xffff0000, v48
    v_and_b32 v95, 0xffff0000, v49
    v_and_b32 v103, 0xffff0000, v50
    v_and_b32 v111, 0xffff0000, v51
    v_sub_f32 v86, v84, v86
    v_sub_f32 v94, v92, v94
    v_sub_f32 v102, v100, v102
    v_sub_f32 v110, v108, v110
    v_sub_f32 v87, v85, v87
    v_sub_f32 v95, v93, v95
    v_sub_f32 v103, v101, v103
    v_sub_f32 v111, v109, v111
    v_cvt_pk_bf16_f32 v52, v86, v87
    v_cvt_pk_bf16_f32 v53, v94, v95
    v_cvt_pk_bf16_f32 v54, v102, v103
    v_cvt_pk_bf16_f32 v55, v110, v111
    v_mul_f32 v80, v32, v7
    v_mul_f32 v88, v40, v7
    v_mul_f32 v96, v112, v7
    v_mul_f32 v104, v120, v7
    v_mul_f32 v81, v33, v7
    v_mul_f32 v89, v41, v7
    v_mul_f32 v97, v113, v7
    v_mul_f32 v105, v121, v7
    v_exp_f32 v80, v80
    v_exp_f32 v88, v88
    v_exp_f32 v96, v96
    v_exp_f32 v104, v104
    v_fract_f32 v81, v81
    v_fract_f32 v89, v89
    v_fract_f32 v97, v97
    v_fract_f32 v105, v105
    v_sin_f32 v82, v81
    v_sin_f32 v90, v89
    v_sin_f32 v98, v97
    v_sin_f32 v106, v105
    v_cos_f32 v83, v81
    v_cos_f32 v91, v89
    v_cos_f32 v99, v97
    v_cos_f32 v107, v105
    v_mul_f32 v84, v83, v80
    v_mul_f32 v92, v91, v88
    v_mul_f32 v100, v99, v96
    v_mul_f32 v108, v107, v104
    v_mul_f32 v85, v82, v80
    v_mul_f32 v93, v90, v88
    v_mul_f32 v101, v98, v96
    v_mul_f32 v109, v106, v104
    v_cvt_pk_bf16_f32 v56, v84, v85
    v_cvt_pk_bf16_f32 v57, v92, v93
    v_cvt_pk_bf16_f32 v58, v100, v101
    v_cvt_pk_bf16_f32 v59, v108, v109
    v_lshlrev_b32 v86, 16, v56
    v_lshlrev_b32 v94, 16, v57
    v_lshlrev_b32 v102, 16, v58
    v_lshlrev_b32 v110, 16, v59
    v_and_b32 v87, 0xffff0000, v56
    v_and_b32 v95, 0xffff0000, v57
    v_and_b32 v103, 0xffff0000, v58
    v_and_b32 v111, 0xffff0000, v59
    v_sub_f32 v86, v84, v86
    v_sub_f32 v94, v92, v94
    v_sub_f32 v102, v100, v102
    v_sub_f32 v110, v108, v110
    v_sub_f32 v87, v85, v87
    v_sub_f32 v95, v93, v95
    v_sub_f32 v103, v101, v103
    v_sub_f32 v111, v109, v111
    v_cvt_pk_bf16_f32 v60, v86, v87
    v_cvt_pk_bf16_f32 v61, v94, v95
    v_cvt_pk_bf16_f32 v62, v102, v103
    v_cvt_pk_bf16_f32 v63, v110, v111
    v_mul_f32 v82, v84, v36
    v_mul_f32 v90, v92, v44
    v_mul_f32 v98, v100, v116
    v_mul_f32 v106, v108, v124
    v_mul_f32 v83, v84, v37
    v_mul_f32 v91, v92, v45
    v_mul_f32 v99, v100, v117
    v_mul_f32 v107, v108, v125
    v_fma_f32 v82, -v85, v37, v82
    v_fma_f32 v90, -v93, v45, v90
    v_fma_f32 v98, -v101, v117, v98
    v_fma_f32 v106, -v109, v125, v106
    v_fma_f32 v83, v85, v36, v83
    v_fma_f32 v91, v93, v44, v91
    v_fma_f32 v99, v101, v116, v99
    v_fma_f32 v107, v109, v124, v107
    v_mov_b32 v84, v82
    v_mov_b32 v92, v90
    v_mov_b32 v100, v98
    v_mov_b32 v108, v106
    v_mov_b32 v85, v83
    v_mov_b32 v93, v91
    v_mov_b32 v101, v99
    v_mov_b32 v109, v107
    v_cvt_pk_bf16_f32 v64, v84, v85
    v_cvt_pk_bf16_f32 v65, v92, v93
    v_cvt_pk_bf16_f32 v66, v100, v101
    v_cvt_pk_bf16_f32 v67, v108, v109
    v_lshlrev_b32 v86, 16, v64
    v_lshlrev_b32 v94, 16, v65
    v_lshlrev_b32 v102, 16, v66
    v_lshlrev_b32 v110, 16, v67
    v_and_b32 v87, 0xffff0000, v64
    v_and_b32 v95, 0xffff0000, v65
    v_and_b32 v103, 0xffff0000, v66
    v_and_b32 v111, 0xffff0000, v67
    v_sub_f32 v86, v84, v86
    v_sub_f32 v94, v92, v94
    v_sub_f32 v102, v100, v102
    v_sub_f32 v110, v108, v110
    v_sub_f32 v87, v85, v87
    v_sub_f32 v95, v93, v95
    v_sub_f32 v103, v101, v103
    v_sub_f32 v111, v109, v111
    v_cvt_pk_bf16_f32 v68, v86, v87
    v_cvt_pk_bf16_f32 v69, v94, v95
    v_cvt_pk_bf16_f32 v70, v102, v103
    v_cvt_pk_bf16_f32 v71, v110, v111
    s_nop 1
    v_mfma_f32_32x32x16_bf16 v[128:143], v[56:59], v[48:51], v[128:143]
    v_mfma_f32_32x32x16_bf16 v[128:143], v[56:59], v[52:55], v[128:143]
    v_mfma_f32_32x32x16_bf16 v[128:143], v[60:63], v[48:51], v[128:143]
    v_mfma_f32_32x32x16_bf16 v[144:159], v[64:67], v[48:51], v[144:159]
    v_mfma_f32_32x32x16_bf16 v[144:159], v[64:67], v[52:55], v[144:159]
    v_mfma_f32_32x32x16_bf16 v[144:159], v[68:71], v[48:51], v[144:159]
    ds_read_b128 v[32:35], v9 offset:37888
    ds_read_b64 v[36:37], v9 offset:37904
    ds_read_b128 v[40:43], v9 offset:37920
    ds_read_b64 v[44:45], v9 offset:37936
    ds_read_b128 v[112:115], v9 offset:37952
    ds_read_b64 v[116:117], v9 offset:37968
    ds_read_b128 v[120:123], v9 offset:37984
    ds_read_b64 v[124:125], v9 offset:38000
    s_waitcnt lgkmcnt(0)
    v_mul_f32 v80, v32, v6
    v_mul_f32 v88, v40, v6
    v_mul_f32 v96, v112, v6
    v_mul_f32 v104, v120, v6
    v_mul_f32 v81, v33, v6
    v_mul_f32 v89, v41, v6
    v_mul_f32 v97, v113, v6
    v_mul_f32 v105, v121, v6
    v_exp_f32 v80, v80
    v_exp_f32 v88, v88
    v_exp_f32 v96, v96
    v_exp_f32 v104, v104
    v_fract_f32 v81, v81
    v_fract_f32 v89, v89
    v_fract_f32 v97, v97
    v_fract_f32 v105, v105
    v_sin_f32 v82, v81
    v_sin_f32 v90, v89
    v_sin_f32 v98, v97
    v_sin_f32 v106, v105
    v_cos_f32 v83, v81
    v_cos_f32 v91, v89
    v_cos_f32 v99, v97
    v_cos_f32 v107, v105
    v_mul_f32 v84, v34, v83
    v_mul_f32 v92, v42, v91
    v_mul_f32 v100, v114, v99
    v_mul_f32 v108, v122, v107
    v_mul_f32 v85, v34, v82
    v_mul_f32 v93, v42, v90
    v_mul_f32 v101, v114, v98
    v_mul_f32 v109, v122, v106
    v_fma_f32 v84, -v35, v82, v84
    v_fma_f32 v92, -v43, v90, v92
    v_fma_f32 v100, -v115, v98, v100
    v_fma_f32 v108, -v123, v106, v108
    v_fma_f32 v85, v35, v83, v85
    v_fma_f32 v93, v43, v91, v93
    v_fma_f32 v101, v115, v99, v101
    v_fma_f32 v109, v123, v107, v109
    v_mul_f32 v84, v84, v80
    v_mul_f32 v92, v92, v88
    v_mul_f32 v100, v100, v96
    v_mul_f32 v108, v108, v104
    v_mul_f32 v85, -v85, v80
    v_mul_f32 v93, -v93, v88
    v_mul_f32 v101, -v101, v96
    v_mul_f32 v109, -v109, v104
    v_cvt_pk_bf16_f32 v48, v84, v85
    v_cvt_pk_bf16_f32 v49, v92, v93
    v_cvt_pk_bf16_f32 v50, v100, v101
    v_cvt_pk_bf16_f32 v51, v108, v109
    v_lshlrev_b32 v86, 16, v48
    v_lshlrev_b32 v94, 16, v49
    v_lshlrev_b32 v102, 16, v50
    v_lshlrev_b32 v110, 16, v51
    v_and_b32 v87, 0xffff0000, v48
    v_and_b32 v95, 0xffff0000, v49
    v_and_b32 v103, 0xffff0000, v50
    v_and_b32 v111, 0xffff0000, v51
    v_sub_f32 v86, v84, v86
    v_sub_f32 v94, v92, v94
    v_sub_f32 v102, v100, v102
    v_sub_f32 v110, v108, v110
    v_sub_f32 v87, v85, v87
    v_sub_f32 v95, v93, v95
    v_sub_f32 v103, v101, v103
    v_sub_f32 v111, v109, v111
    v_cvt_pk_bf16_f32 v52, v86, v87
    v_cvt_pk_bf16_f32 v53, v94, v95
    v_cvt_pk_bf16_f32 v54, v102, v103
    v_cvt_pk_bf16_f32 v55, v110, v111
    v_mul_f32 v80, v32, v7
    v_mul_f32 v88, v40, v7
    v_mul_f32 v96, v112, v7
    v_mul_f32 v104, v120, v7
    v_mul_f32 v81, v33, v7
    v_mul_f32 v89, v41, v7
    v_mul_f32 v97, v113, v7
    v_mul_f32 v105, v121, v7
    v_exp_f32 v80, v80
    v_exp_f32 v88, v88
    v_exp_f32 v96, v96
    v_exp_f32 v104, v104
    v_fract_f32 v81, v81
    v_fract_f32 v89, v89
    v_fract_f32 v97, v97
    v_fract_f32 v105, v105
    v_sin_f32 v82, v81
    v_sin_f32 v90, v89
    v_sin_f32 v98, v97
    v_sin_f32 v106, v105
    v_cos_f32 v83, v81
    v_cos_f32 v91, v89
    v_cos_f32 v99, v97
    v_cos_f32 v107, v105
    v_mul_f32 v84, v83, v80
    v_mul_f32 v92, v91, v88
    v_mul_f32 v100, v99, v96
    v_mul_f32 v108, v107, v104
    v_mul_f32 v85, v82, v80
    v_mul_f32 v93, v90, v88
    v_mul_f32 v101, v98, v96
    v_mul_f32 v109, v106, v104
    v_cvt_pk_bf16_f32 v56, v84, v85
    v_cvt_pk_bf16_f32 v57, v92, v93
    v_cvt_pk_bf16_f32 v58, v100, v101
    v_cvt_pk_bf16_f32 v59, v108, v109
    v_lshlrev_b32 v86, 16, v56
    v_lshlrev_b32 v94, 16, v57
    v_lshlrev_b32 v102, 16, v58
    v_lshlrev_b32 v110, 16, v59
    v_and_b32 v87, 0xffff0000, v56
    v_and_b32 v95, 0xffff0000, v57
    v_and_b32 v103, 0xffff0000, v58
    v_and_b32 v111, 0xffff0000, v59
    v_sub_f32 v86, v84, v86
    v_sub_f32 v94, v92, v94
    v_sub_f32 v102, v100, v102
    v_sub_f32 v110, v108, v110
    v_sub_f32 v87, v85, v87
    v_sub_f32 v95, v93, v95
    v_sub_f32 v103, v101, v103
    v_sub_f32 v111, v109, v111
    v_cvt_pk_bf16_f32 v60, v86, v87
    v_cvt_pk_bf16_f32 v61, v94, v95
    v_cvt_pk_bf16_f32 v62, v102, v103
    v_cvt_pk_bf16_f32 v63, v110, v111
    v_mul_f32 v82, v84, v36
    v_mul_f32 v90, v92, v44
    v_mul_f32 v98, v100, v116
    v_mul_f32 v106, v108, v124
    v_mul_f32 v83, v84, v37
    v_mul_f32 v91, v92, v45
    v_mul_f32 v99, v100, v117
    v_mul_f32 v107, v108, v125
    v_fma_f32 v82, -v85, v37, v82
    v_fma_f32 v90, -v93, v45, v90
    v_fma_f32 v98, -v101, v117, v98
    v_fma_f32 v106, -v109, v125, v106
    v_fma_f32 v83, v85, v36, v83
    v_fma_f32 v91, v93, v44, v91
    v_fma_f32 v99, v101, v116, v99
    v_fma_f32 v107, v109, v124, v107
    v_mov_b32 v84, v82
    v_mov_b32 v92, v90
    v_mov_b32 v100, v98
    v_mov_b32 v108, v106
    v_mov_b32 v85, v83
    v_mov_b32 v93, v91
    v_mov_b32 v101, v99
    v_mov_b32 v109, v107
    v_cvt_pk_bf16_f32 v64, v84, v85
    v_cvt_pk_bf16_f32 v65, v92, v93
    v_cvt_pk_bf16_f32 v66, v100, v101
    v_cvt_pk_bf16_f32 v67, v108, v109
    v_lshlrev_b32 v86, 16, v64
    v_lshlrev_b32 v94, 16, v65
    v_lshlrev_b32 v102, 16, v66
    v_lshlrev_b32 v110, 16, v67
    v_and_b32 v87, 0xffff0000, v64
    v_and_b32 v95, 0xffff0000, v65
    v_and_b32 v103, 0xffff0000, v66
    v_and_b32 v111, 0xffff0000, v67
    v_sub_f32 v86, v84, v86
    v_sub_f32 v94, v92, v94
    v_sub_f32 v102, v100, v102
    v_sub_f32 v110, v108, v110
    v_sub_f32 v87, v85, v87
    v_sub_f32 v95, v93, v95
    v_sub_f32 v103, v101, v103
    v_sub_f32 v111, v109, v111
    v_cvt_pk_bf16_f32 v68, v86, v87
    v_cvt_pk_bf16_f32 v69, v94, v95
    v_cvt_pk_bf16_f32 v70, v102, v103
    v_cvt_pk_bf16_f32 v71, v110, v111
    s_nop 1
    v_mfma_f32_32x32x16_bf16 v[128:143], v[56:59], v[48:51], v[128:143]
    v_mfma_f32_32x32x16_bf16 v[128:143], v[56:59], v[52:55], v[128:143]
    v_mfma_f32_32x32x16_bf16 v[128:143], v[60:63], v[48:51], v[128:143]
    v_mfma_f32_32x32x16_bf16 v[144:159], v[64:67], v[48:51], v[144:159]
    v_mfma_f32_32x32x16_bf16 v[144:159], v[64:67], v[52:55], v[144:159]
    v_mfma_f32_32x32x16_bf16 v[144:159], v[68:71], v[48:51], v[144:159]
    ds_read_b128 v[32:35], v9 offset:38144
    ds_read_b64 v[36:37], v9 offset:38160
    ds_read_b128 v[40:43], v9 offset:38176
    ds_read_b64 v[44:45], v9 offset:38192
    ds_read_b128 v[112:115], v9 offset:38208
    ds_read_b64 v[116:117], v9 offset:38224
    ds_read_b128 v[120:123], v9 offset:38240
    ds_read_b64 v[124:125], v9 offset:38256
    s_waitcnt lgkmcnt(0)
    v_mul_f32 v80, v32, v6
    v_mul_f32 v88, v40, v6
    v_mul_f32 v96, v112, v6
    v_mul_f32 v104, v120, v6
    v_mul_f32 v81, v33, v6
    v_mul_f32 v89, v41, v6
    v_mul_f32 v97, v113, v6
    v_mul_f32 v105, v121, v6
    v_exp_f32 v80, v80
    v_exp_f32 v88, v88
    v_exp_f32 v96, v96
    v_exp_f32 v104, v104
    v_fract_f32 v81, v81
    v_fract_f32 v89, v89
    v_fract_f32 v97, v97
    v_fract_f32 v105, v105
    v_sin_f32 v82, v81
    v_sin_f32 v90, v89
    v_sin_f32 v98, v97
    v_sin_f32 v106, v105
    v_cos_f32 v83, v81
    v_cos_f32 v91, v89
    v_cos_f32 v99, v97
    v_cos_f32 v107, v105
    v_mul_f32 v84, v34, v83
    v_mul_f32 v92, v42, v91
    v_mul_f32 v100, v114, v99
    v_mul_f32 v108, v122, v107
    v_mul_f32 v85, v34, v82
    v_mul_f32 v93, v42, v90
    v_mul_f32 v101, v114, v98
    v_mul_f32 v109, v122, v106
    v_fma_f32 v84, -v35, v82, v84
    v_fma_f32 v92, -v43, v90, v92
    v_fma_f32 v100, -v115, v98, v100
    v_fma_f32 v108, -v123, v106, v108
    v_fma_f32 v85, v35, v83, v85
    v_fma_f32 v93, v43, v91, v93
    v_fma_f32 v101, v115, v99, v101
    v_fma_f32 v109, v123, v107, v109
    v_mul_f32 v84, v84, v80
    v_mul_f32 v92, v92, v88
    v_mul_f32 v100, v100, v96
    v_mul_f32 v108, v108, v104
    v_mul_f32 v85, -v85, v80
    v_mul_f32 v93, -v93, v88
    v_mul_f32 v101, -v101, v96
    v_mul_f32 v109, -v109, v104
    v_cvt_pk_bf16_f32 v48, v84, v85
    v_cvt_pk_bf16_f32 v49, v92, v93
    v_cvt_pk_bf16_f32 v50, v100, v101
    v_cvt_pk_bf16_f32 v51, v108, v109
    v_lshlrev_b32 v86, 16, v48
    v_lshlrev_b32 v94, 16, v49
    v_lshlrev_b32 v102, 16, v50
    v_lshlrev_b32 v110, 16, v51
    v_and_b32 v87, 0xffff0000, v48
    v_and_b32 v95, 0xffff0000, v49
    v_and_b32 v103, 0xffff0000, v50
    v_and_b32 v111, 0xffff0000, v51
    v_sub_f32 v86, v84, v86
    v_sub_f32 v94, v92, v94
    v_sub_f32 v102, v100, v102
    v_sub_f32 v110, v108, v110
    v_sub_f32 v87, v85, v87
    v_sub_f32 v95, v93, v95
    v_sub_f32 v103, v101, v103
    v_sub_f32 v111, v109, v111
    v_cvt_pk_bf16_f32 v52, v86, v87
    v_cvt_pk_bf16_f32 v53, v94, v95
    v_cvt_pk_bf16_f32 v54, v102, v103
    v_cvt_pk_bf16_f32 v55, v110, v111
    v_mul_f32 v80, v32, v7
    v_mul_f32 v88, v40, v7
    v_mul_f32 v96, v112, v7
    v_mul_f32 v104, v120, v7
    v_mul_f32 v81, v33, v7
    v_mul_f32 v89, v41, v7
    v_mul_f32 v97, v113, v7
    v_mul_f32 v105, v121, v7
    v_exp_f32 v80, v80
    v_exp_f32 v88, v88
    v_exp_f32 v96, v96
    v_exp_f32 v104, v104
    v_fract_f32 v81, v81
    v_fract_f32 v89, v89
    v_fract_f32 v97, v97
    v_fract_f32 v105, v105
    v_sin_f32 v82, v81
    v_sin_f32 v90, v89
    v_sin_f32 v98, v97
    v_sin_f32 v106, v105
    v_cos_f32 v83, v81
    v_cos_f32 v91, v89
    v_cos_f32 v99, v97
    v_cos_f32 v107, v105
    v_mul_f32 v84, v83, v80
    v_mul_f32 v92, v91, v88
    v_mul_f32 v100, v99, v96
    v_mul_f32 v108, v107, v104
    v_mul_f32 v85, v82, v80
    v_mul_f32 v93, v90, v88
    v_mul_f32 v101, v98, v96
    v_mul_f32 v109, v106, v104
    v_cvt_pk_bf16_f32 v56, v84, v85
    v_cvt_pk_bf16_f32 v57, v92, v93
    v_cvt_pk_bf16_f32 v58, v100, v101
    v_cvt_pk_bf16_f32 v59, v108, v109
    v_lshlrev_b32 v86, 16, v56
    v_lshlrev_b32 v94, 16, v57
    v_lshlrev_b32 v102, 16, v58
    v_lshlrev_b32 v110, 16, v59
    v_and_b32 v87, 0xffff0000, v56
    v_and_b32 v95, 0xffff0000, v57
    v_and_b32 v103, 0xffff0000, v58
    v_and_b32 v111, 0xffff0000, v59
    v_sub_f32 v86, v84, v86
    v_sub_f32 v94, v92, v94
    v_sub_f32 v102, v100, v102
    v_sub_f32 v110, v108, v110
    v_sub_f32 v87, v85, v87
    v_sub_f32 v95, v93, v95
    v_sub_f32 v103, v101, v103
    v_sub_f32 v111, v109, v111
    v_cvt_pk_bf16_f32 v60, v86, v87
    v_cvt_pk_bf16_f32 v61, v94, v95
    v_cvt_pk_bf16_f32 v62, v102, v103
    v_cvt_pk_bf16_f32 v63, v110, v111
    v_mul_f32 v82, v84, v36
    v_mul_f32 v90, v92, v44
    v_mul_f32 v98, v100, v116
    v_mul_f32 v106, v108, v124
    v_mul_f32 v83, v84, v37
    v_mul_f32 v91, v92, v45
    v_mul_f32 v99, v100, v117
    v_mul_f32 v107, v108, v125
    v_fma_f32 v82, -v85, v37, v82
    v_fma_f32 v90, -v93, v45, v90
    v_fma_f32 v98, -v101, v117, v98
    v_fma_f32 v106, -v109, v125, v106
    v_fma_f32 v83, v85, v36, v83
    v_fma_f32 v91, v93, v44, v91
    v_fma_f32 v99, v101, v116, v99
    v_fma_f32 v107, v109, v124, v107
    v_mov_b32 v84, v82
    v_mov_b32 v92, v90
    v_mov_b32 v100, v98
    v_mov_b32 v108, v106
    v_mov_b32 v85, v83
    v_mov_b32 v93, v91
    v_mov_b32 v101, v99
    v_mov_b32 v109, v107
    v_cvt_pk_bf16_f32 v64, v84, v85
    v_cvt_pk_bf16_f32 v65, v92, v93
    v_cvt_pk_bf16_f32 v66, v100, v101
    v_cvt_pk_bf16_f32 v67, v108, v109
    v_lshlrev_b32 v86, 16, v64
    v_lshlrev_b32 v94, 16, v65
    v_lshlrev_b32 v102, 16, v66
    v_lshlrev_b32 v110, 16, v67
    v_and_b32 v87, 0xffff0000, v64
    v_and_b32 v95, 0xffff0000, v65
    v_and_b32 v103, 0xffff0000, v66
    v_and_b32 v111, 0xffff0000, v67
    v_sub_f32 v86, v84, v86
    v_sub_f32 v94, v92, v94
    v_sub_f32 v102, v100, v102
    v_sub_f32 v110, v108, v110
    v_sub_f32 v87, v85, v87
    v_sub_f32 v95, v93, v95
    v_sub_f32 v103, v101, v103
    v_sub_f32 v111, v109, v111
    v_cvt_pk_bf16_f32 v68, v86, v87
    v_cvt_pk_bf16_f32 v69, v94, v95
    v_cvt_pk_bf16_f32 v70, v102, v103
    v_cvt_pk_bf16_f32 v71, v110, v111
    s_nop 1
    v_mfma_f32_32x32x16_bf16 v[128:143], v[56:59], v[48:51], v[128:143]
    v_mfma_f32_32x32x16_bf16 v[128:143], v[56:59], v[52:55], v[128:143]
    v_mfma_f32_32x32x16_bf16 v[128:143], v[60:63], v[48:51], v[128:143]
    v_mfma_f32_32x32x16_bf16 v[144:159], v[64:67], v[48:51], v[144:159]
    v_mfma_f32_32x32x16_bf16 v[144:159], v[64:67], v[52:55], v[144:159]
    v_mfma_f32_32x32x16_bf16 v[144:159], v[68:71], v[48:51], v[144:159]
    s_nop 15
    v_lshlrev_b32 v10, 9, v5
    v_lshlrev_b32 v9, 2, v4
    v_add_u32 v9, v9, v10
    v_mul_u32_u24 v10, 9216, v2
    v_add_u32 v9, v9, v10
    ds_write_b32 v9, v128 offset:0
    ds_write_b32 v9, v129 offset:128
    ds_write_b32 v9, v130 offset:256
    ds_write_b32 v9, v131 offset:384
    ds_write_b32 v9, v132 offset:1024
    ds_write_b32 v9, v133 offset:1152
    ds_write_b32 v9, v134 offset:1280
    ds_write_b32 v9, v135 offset:1408
    ds_write_b32 v9, v136 offset:2048
    ds_write_b32 v9, v137 offset:2176
    ds_write_b32 v9, v138 offset:2304
    ds_write_b32 v9, v139 offset:2432
    ds_write_b32 v9, v140 offset:3072
    ds_write_b32 v9, v141 offset:3200
    ds_write_b32 v9, v142 offset:3328
    ds_write_b32 v9, v143 offset:3456
    ds_write_b32 v9, v144 offset:4096
    ds_write_b32 v9, v145 offset:4224
    ds_write_b32 v9, v146 offset:4352
    ds_write_b32 v9, v147 offset:4480
    ds_write_b32 v9, v148 offset:5120
    ds_write_b32 v9, v149 offset:5248
    ds_write_b32 v9, v150 offset:5376
    ds_write_b32 v9, v151 offset:5504
    ds_write_b32 v9, v152 offset:6144
    ds_write_b32 v9, v153 offset:6272
    ds_write_b32 v9, v154 offset:6400
    ds_write_b32 v9, v155 offset:6528
    ds_write_b32 v9, v156 offset:7168
    ds_write_b32 v9, v157 offset:7296
    ds_write_b32 v9, v158 offset:7424
    ds_write_b32 v9, v159 offset:7552
    v_mov_b32 v24, s46
    ds_write_b32 v10, v24 offset:8192
    s_waitcnt lgkmcnt(0)
    s_barrier
    v_lshlrev_b32 v9, 5, v0
    ds_read_b128 v[32:35], v9 offset:0
    ds_read_b128 v[36:39], v9 offset:16
    ds_read_b128 v[40:43], v9 offset:9216
    ds_read_b128 v[44:47], v9 offset:9232
    ds_read_b128 v[48:51], v9 offset:18432
    ds_read_b128 v[52:55], v9 offset:18448
    ds_read_b128 v[56:59], v9 offset:27648
    ds_read_b128 v[60:63], v9 offset:27664
    v_mov_b32 v10, 0
    ds_read_b32 v64, v10 offset:8192
    ds_read_b32 v65, v10 offset:17408
    ds_read_b32 v66, v10 offset:26624
    ds_read_b32 v67, v10 offset:35840
    s_waitcnt lgkmcnt(0)
    v_add_f32 v32, v32, v40
    v_add_f32 v48, v48, v56
    v_add_f32 v32, v32, v48
    v_add_f32 v33, v33, v41
    v_add_f32 v49, v49, v57
    v_add_f32 v33, v33, v49
    v_add_f32 v34, v34, v42
    v_add_f32 v50, v50, v58
    v_add_f32 v34, v34, v50
    v_add_f32 v35, v35, v43
    v_add_f32 v51, v51, v59
    v_add_f32 v35, v35, v51
    v_add_f32 v36, v36, v44
    v_add_f32 v52, v52, v60
    v_add_f32 v36, v36, v52
    v_add_f32 v37, v37, v45
    v_add_f32 v53, v53, v61
    v_add_f32 v37, v37, v53
    v_add_f32 v38, v38, v46
    v_add_f32 v54, v54, v62
    v_add_f32 v38, v38, v54
    v_add_f32 v39, v39, v47
    v_add_f32 v55, v55, v63
    v_add_f32 v39, v39, v55
    ds_write_b128 v9, v[32:35] offset:0
    ds_write_b128 v9, v[36:39] offset:16
    v_add_f32 v64, v64, v65
    v_add_f32 v66, v66, v67
    v_add_f32 v64, v64, v66
    ds_write_b32 v10, v64 offset:8192
    s_waitcnt lgkmcnt(0)
    s_barrier
    v_add_u32 v3, 0, v0
    v_lshlrev_b32 v4, 1, v3
    v_add_u32 v10, 0, v4
    v_subrev_u32 v10, 31, v10
    v_add_u32 v11, 1, v4
    v_subrev_u32 v11, 31, v11
    v_add_u32 v12, 2, v4
    v_subrev_u32 v12, 31, v12
    v_cmp_gt_u32 vcc, 2048, v10
    s_nop 1
    v_cndmask_b32 v13, 0, v10, vcc
    v_cvt_f32_u32 v13, v13
    v_cvt_pk_bf16_f32 v13, v13, v13
    v_lshlrev_b32 v13, 16, v13
    v_cvt_u32_f32 v13, v13
    v_lshlrev_b32 v13, 2, v13
    ds_read_b32 v16, v13 offset:0
    s_waitcnt lgkmcnt(0)
    v_cndmask_b32 v16, 0, v16, vcc
    v_cmp_gt_u32 vcc, 2048, v11
    s_nop 1
    v_cndmask_b32 v14, 0, v11, vcc
    v_cvt_f32_u32 v14, v14
    v_cvt_pk_bf16_f32 v14, v14, v14
    v_lshlrev_b32 v14, 16, v14
    v_cvt_u32_f32 v14, v14
    v_lshlrev_b32 v14, 2, v14
    ds_read_b32 v17, v14 offset:0
    s_waitcnt lgkmcnt(0)
    v_cndmask_b32 v17, 0, v17, vcc
    v_cmp_gt_u32 vcc, 2048, v12
    s_nop 1
    v_cndmask_b32 v15, 0, v12, vcc
    v_cvt_f32_u32 v15, v15
    v_cvt_pk_bf16_f32 v15, v15, v15
    v_lshlrev_b32 v15, 16, v15
    v_cvt_u32_f32 v15, v15
    v_lshlrev_b32 v15, 2, v15
    ds_read_b32 v18, v15 offset:0
    s_waitcnt lgkmcnt(0)
    v_cndmask_b32 v18, 0, v18, vcc
    v_cvt_pk_bf16_f32 v20, v16, v17
    v_cvt_pk_bf16_f32 v21, v17, v18
    v_lshlrev_b32 v22, 16, v20
    v_and_b32 v23, 0xffff0000, v20
    v_and_b32 v24, 0xffff0000, v21
    v_sub_f32 v22, v16, v22
    v_sub_f32 v23, v17, v23
    v_sub_f32 v24, v18, v24
    v_cvt_pk_bf16_f32 v25, v22, v23
    v_cvt_pk_bf16_f32 v26, v23, v24
    v_lshlrev_b32 v4, 2, v3
    ds_write_b32 v4, v20 offset:9216
    ds_write_b32 v4, v21 offset:13376
    ds_write_b32 v4, v25 offset:17536
    ds_write_b32 v4, v26 offset:21696
    v_add_u32 v3, 256, v0
    v_lshlrev_b32 v4, 1, v3
    v_add_u32 v10, 0, v4
    v_subrev_u32 v10, 31, v10
    v_add_u32 v11, 1, v4
    v_subrev_u32 v11, 31, v11
    v_add_u32 v12, 2, v4
    v_subrev_u32 v12, 31, v12
    v_cmp_gt_u32 vcc, 2048, v10
    s_nop 1
    v_cndmask_b32 v13, 0, v10, vcc
    v_cvt_f32_u32 v13, v13
    v_cvt_pk_bf16_f32 v13, v13, v13
    v_lshlrev_b32 v13, 16, v13
    v_cvt_u32_f32 v13, v13
    v_lshlrev_b32 v13, 2, v13
    ds_read_b32 v16, v13 offset:0
    s_waitcnt lgkmcnt(0)
    v_cndmask_b32 v16, 0, v16, vcc
    v_cmp_gt_u32 vcc, 2048, v11
    s_nop 1
    v_cndmask_b32 v14, 0, v11, vcc
    v_cvt_f32_u32 v14, v14
    v_cvt_pk_bf16_f32 v14, v14, v14
    v_lshlrev_b32 v14, 16, v14
    v_cvt_u32_f32 v14, v14
    v_lshlrev_b32 v14, 2, v14
    ds_read_b32 v17, v14 offset:0
    s_waitcnt lgkmcnt(0)
    v_cndmask_b32 v17, 0, v17, vcc
    v_cmp_gt_u32 vcc, 2048, v12
    s_nop 1
    v_cndmask_b32 v15, 0, v12, vcc
    v_cvt_f32_u32 v15, v15
    v_cvt_pk_bf16_f32 v15, v15, v15
    v_lshlrev_b32 v15, 16, v15
    v_cvt_u32_f32 v15, v15
    v_lshlrev_b32 v15, 2, v15
    ds_read_b32 v18, v15 offset:0
    s_waitcnt lgkmcnt(0)
    v_cndmask_b32 v18, 0, v18, vcc
    v_cvt_pk_bf16_f32 v20, v16, v17
    v_cvt_pk_bf16_f32 v21, v17, v18
    v_lshlrev_b32 v22, 16, v20
    v_and_b32 v23, 0xffff0000, v20
    v_and_b32 v24, 0xffff0000, v21
    v_sub_f32 v22, v16, v22
    v_sub_f32 v23, v17, v23
    v_sub_f32 v24, v18, v24
    v_cvt_pk_bf16_f32 v25, v22, v23
    v_cvt_pk_bf16_f32 v26, v23, v24
    v_lshlrev_b32 v4, 2, v3
    ds_write_b32 v4, v20 offset:9216
    ds_write_b32 v4, v21 offset:13376
    ds_write_b32 v4, v25 offset:17536
    ds_write_b32 v4, v26 offset:21696
    v_add_u32 v3, 512, v0
    v_lshlrev_b32 v4, 1, v3
    v_add_u32 v10, 0, v4
    v_subrev_u32 v10, 31, v10
    v_add_u32 v11, 1, v4
    v_subrev_u32 v11, 31, v11
    v_add_u32 v12, 2, v4
    v_subrev_u32 v12, 31, v12
    v_cmp_gt_u32 vcc, 2048, v10
    s_nop 1
    v_cndmask_b32 v13, 0, v10, vcc
    v_cvt_f32_u32 v13, v13
    v_cvt_pk_bf16_f32 v13, v13, v13
    v_lshlrev_b32 v13, 16, v13
    v_cvt_u32_f32 v13, v13
    v_lshlrev_b32 v13, 2, v13
    ds_read_b32 v16, v13 offset:0
    s_waitcnt lgkmcnt(0)
    v_cndmask_b32 v16, 0, v16, vcc
    v_cmp_gt_u32 vcc, 2048, v11
    s_nop 1
    v_cndmask_b32 v14, 0, v11, vcc
    v_cvt_f32_u32 v14, v14
    v_cvt_pk_bf16_f32 v14, v14, v14
    v_lshlrev_b32 v14, 16, v14
    v_cvt_u32_f32 v14, v14
    v_lshlrev_b32 v14, 2, v14
    ds_read_b32 v17, v14 offset:0
    s_waitcnt lgkmcnt(0)
    v_cndmask_b32 v17, 0, v17, vcc
    v_cmp_gt_u32 vcc, 2048, v12
    s_nop 1
    v_cndmask_b32 v15, 0, v12, vcc
    v_cvt_f32_u32 v15, v15
    v_cvt_pk_bf16_f32 v15, v15, v15
    v_lshlrev_b32 v15, 16, v15
    v_cvt_u32_f32 v15, v15
    v_lshlrev_b32 v15, 2, v15
    ds_read_b32 v18, v15 offset:0
    s_waitcnt lgkmcnt(0)
    v_cndmask_b32 v18, 0, v18, vcc
    v_cvt_pk_bf16_f32 v20, v16, v17
    v_cvt_pk_bf16_f32 v21, v17, v18
    v_lshlrev_b32 v22, 16, v20
    v_and_b32 v23, 0xffff0000, v20
    v_and_b32 v24, 0xffff0000, v21
    v_sub_f32 v22, v16, v22
    v_sub_f32 v23, v17, v23
    v_sub_f32 v24, v18, v24
    v_cvt_pk_bf16_f32 v25, v22, v23
    v_cvt_pk_bf16_f32 v26, v23, v24
    v_lshlrev_b32 v4, 2, v3
    ds_write_b32 v4, v20 offset:9216
    ds_write_b32 v4, v21 offset:13376
    ds_write_b32 v4, v25 offset:17536
    ds_write_b32 v4, v26 offset:21696
    v_add_u32 v3, 768, v0
    v_lshlrev_b32 v4, 1, v3
    v_add_u32 v10, 0, v4
    v_subrev_u32 v10, 31, v10
    v_add_u32 v11, 1, v4
    v_subrev_u32 v11, 31, v11
    v_add_u32 v12, 2, v4
    v_subrev_u32 v12, 31, v12
    v_cmp_gt_u32 vcc, 2048, v10
    s_nop 1
    v_cndmask_b32 v13, 0, v10, vcc
    v_cvt_f32_u32 v13, v13
    v_cvt_pk_bf16_f32 v13, v13, v13
    v_lshlrev_b32 v13, 16, v13
    v_cvt_u32_f32 v13, v13
    v_lshlrev_b32 v13, 2, v13
    ds_read_b32 v16, v13 offset:0
    s_waitcnt lgkmcnt(0)
    v_cndmask_b32 v16, 0, v16, vcc
    v_cmp_gt_u32 vcc, 2048, v11
    s_nop 1
    v_cndmask_b32 v14, 0, v11, vcc
    v_cvt_f32_u32 v14, v14
    v_cvt_pk_bf16_f32 v14, v14, v14
    v_lshlrev_b32 v14, 16, v14
    v_cvt_u32_f32 v14, v14
    v_lshlrev_b32 v14, 2, v14
    ds_read_b32 v17, v14 offset:0
    s_waitcnt lgkmcnt(0)
    v_cndmask_b32 v17, 0, v17, vcc
    v_cmp_gt_u32 vcc, 2048, v12
    s_nop 1
    v_cndmask_b32 v15, 0, v12, vcc
    v_cvt_f32_u32 v15, v15
    v_cvt_pk_bf16_f32 v15, v15, v15
    v_lshlrev_b32 v15, 16, v15
    v_cvt_u32_f32 v15, v15
    v_lshlrev_b32 v15, 2, v15
    ds_read_b32 v18, v15 offset:0
    s_waitcnt lgkmcnt(0)
    v_cndmask_b32 v18, 0, v18, vcc
    v_cvt_pk_bf16_f32 v20, v16, v17
    v_cvt_pk_bf16_f32 v21, v17, v18
    v_lshlrev_b32 v22, 16, v20
    v_and_b32 v23, 0xffff0000, v20
    v_and_b32 v24, 0xffff0000, v21
    v_sub_f32 v22, v16, v22
    v_sub_f32 v23, v17, v23
    v_sub_f32 v24, v18, v24
    v_cvt_pk_bf16_f32 v25, v22, v23
    v_cvt_pk_bf16_f32 v26, v23, v24
    v_lshlrev_b32 v4, 2, v3
    ds_write_b32 v4, v20 offset:9216
    ds_write_b32 v4, v21 offset:13376
    ds_write_b32 v4, v25 offset:17536
    ds_write_b32 v4, v26 offset:21696
    v_add_u32 v3, 1024, v0
    v_lshlrev_b32 v4, 1, v3
    v_add_u32 v10, 0, v4
    v_subrev_u32 v10, 31, v10
    v_add_u32 v11, 1, v4
    v_subrev_u32 v11, 31, v11
    v_add_u32 v12, 2, v4
    v_subrev_u32 v12, 31, v12
    v_cmp_gt_u32 vcc, 2048, v10
    s_nop 1
    v_cndmask_b32 v13, 0, v10, vcc
    v_cvt_f32_u32 v13, v13
    v_cvt_pk_bf16_f32 v13, v13, v13
    v_lshlrev_b32 v13, 16, v13
    v_cvt_u32_f32 v13, v13
    v_lshlrev_b32 v13, 2, v13
    ds_read_b32 v16, v13 offset:0
    s_waitcnt lgkmcnt(0)
    v_cndmask_b32 v16, 0, v16, vcc
    v_cmp_gt_u32 vcc, 2048, v11
    s_nop 1
    v_cndmask_b32 v14, 0, v11, vcc
    v_cvt_f32_u32 v14, v14
    v_cvt_pk_bf16_f32 v14, v14, v14
    v_lshlrev_b32 v14, 16, v14
    v_cvt_u32_f32 v14, v14
    v_lshlrev_b32 v14, 2, v14
    ds_read_b32 v17, v14 offset:0
    s_waitcnt lgkmcnt(0)
    v_cndmask_b32 v17, 0, v17, vcc
    v_cmp_gt_u32 vcc, 2048, v12
    s_nop 1
    v_cndmask_b32 v15, 0, v12, vcc
    v_cvt_f32_u32 v15, v15
    v_cvt_pk_bf16_f32 v15, v15, v15
    v_lshlrev_b32 v15, 16, v15
    v_cvt_u32_f32 v15, v15
    v_lshlrev_b32 v15, 2, v15
    ds_read_b32 v18, v15 offset:0
    s_waitcnt lgkmcnt(0)
    v_cndmask_b32 v18, 0, v18, vcc
    v_cvt_pk_bf16_f32 v20, v16, v17
    v_cvt_pk_bf16_f32 v21, v17, v18
    v_lshlrev_b32 v22, 16, v20
    v_and_b32 v23, 0xffff0000, v20
    v_and_b32 v24, 0xffff0000, v21
    v_sub_f32 v22, v16, v22
    v_sub_f32 v23, v17, v23
    v_sub_f32 v24, v18, v24
    v_cvt_pk_bf16_f32 v25, v22, v23
    v_cvt_pk_bf16_f32 v26, v23, v24
    v_lshlrev_b32 v4, 2, v3
    v_cmp_gt_u32 vcc, 1040, v3
    s_nop 1
    s_and_saveexec_b64 s[44:45], vcc
    ds_write_b32 v4, v20 offset:9216
    ds_write_b32 v4, v21 offset:13376
    ds_write_b32 v4, v25 offset:17536
    ds_write_b32 v4, v26 offset:21696
    s_mov_b64 exec, s[44:45]
    v_lshrrev_b32 v4, 2, v0
    v_mul_u32_u24 v4, 80, v4
    v_and_b32 v6, 3, v0
    v_lshlrev_b32 v6, 4, v6
    v_add_u32 v4, v4, v6
    v_mov_b32 v36, 0
    v_mov_b32 v37, 0
    v_mov_b32 v38, 0
    v_mov_b32 v39, 0
    v_cmp_gt_u32 vcc, 124, v0
    s_nop 1
    s_and_saveexec_b64 s[44:45], vcc
    ds_write_b128 v4, v[36:39] offset:30976
    s_mov_b64 exec, s[44:45]
    s_waitcnt vmcnt(0)
    v_alignbit_b32 v40, v163, v163, 16
    v_alignbit_b32 v41, v162, v162, 16
    v_alignbit_b32 v42, v161, v161, 16
    v_alignbit_b32 v43, v160, v160, 16
    v_lshlrev_b32 v4, 3, v0
    v_sub_u32 v4, 2040, v4
    v_lshrrev_b32 v6, 5, v4
    v_mul_u32_u24 v6, 80, v6
    v_and_b32 v4, 31, v4
    v_lshlrev_b32 v4, 1, v4
    v_add_u32 v4, v4, v6
    ds_write_b128 v4, v[40:43] offset:25856
    s_waitcnt lgkmcnt(0)
    s_barrier
    v_and_b32 v4, 31, v1
    v_lshrrev_b32 v5, 5, v1
    v_and_b32 v6, 1, v4
    v_mul_u32_u24 v6, 4160, v6
    v_and_b32 v7, 30, v4
    v_lshlrev_b32 v7, 1, v7
    v_add_u32 v6, v6, v7
    v_lshlrev_b32 v7, 4, v5
    v_add_u32 v6, v6, v7
    v_lshlrev_b32 v8, 6, v2
    v_add_u32 v6, v6, v8
    v_add_u32 v6, 9216, v6
    v_add_u32 v8, 8320, v6
    v_sub_u32 v9, 31, v4
    v_mul_u32_u24 v9, 80, v9
    v_add_u32 v9, v9, v7
    v_mul_u32_u24 v10, 80, v2
    v_add_u32 v9, v9, v10
    v_add_u32 v9, 25856, v9
    v_add_u32 v10, 2560, v9
    v_mov_b32 v64, 0
    v_mov_b32 v80, 0
    v_mov_b32 v65, 0
    v_mov_b32 v81, 0
    v_mov_b32 v66, 0
    v_mov_b32 v82, 0
    v_mov_b32 v67, 0
    v_mov_b32 v83, 0
    v_mov_b32 v68, 0
    v_mov_b32 v84, 0
    v_mov_b32 v69, 0
    v_mov_b32 v85, 0
    v_mov_b32 v70, 0
    v_mov_b32 v86, 0
    v_mov_b32 v71, 0
    v_mov_b32 v87, 0
    v_mov_b32 v72, 0
    v_mov_b32 v88, 0
    v_mov_b32 v73, 0
    v_mov_b32 v89, 0
    v_mov_b32 v74, 0
    v_mov_b32 v90, 0
    v_mov_b32 v75, 0
    v_mov_b32 v91, 0
    v_mov_b32 v76, 0
    v_mov_b32 v92, 0
    v_mov_b32 v77, 0
    v_mov_b32 v93, 0
    v_mov_b32 v78, 0
    v_mov_b32 v94, 0
    v_mov_b32 v79, 0
    v_mov_b32 v95, 0
    s_waitcnt lgkmcnt(0)
    ds_read2_b32 v[96:97], v6 offset0:0 offset1:1
    ds_read2_b32 v[98:99], v6 offset0:2 offset1:3
    ds_read2_b32 v[100:101], v8 offset0:0 offset1:1
    ds_read2_b32 v[102:103], v8 offset0:2 offset1:3
    ds_read_b128 v[104:107], v9 offset:0
    ds_read_b128 v[108:111], v10 offset:0
    ds_read2_b32 v[112:113], v6 offset0:8 offset1:9
    ds_read2_b32 v[114:115], v6 offset0:10 offset1:11
    ds_read2_b32 v[116:117], v8 offset0:8 offset1:9
    ds_read2_b32 v[118:119], v8 offset0:10 offset1:11
    ds_read_b128 v[120:123], v9 offset:32
    ds_read_b128 v[124:127], v10 offset:32
    v_add_u32 v6, 256, v6
    v_add_u32 v8, 256, v8
    s_waitcnt lgkmcnt(6)
    v_mfma_f32_32x32x16_bf16 v[64:79], v[96:99], v[104:107], v[64:79]
    v_mfma_f32_32x32x16_bf16 v[64:79], v[100:103], v[104:107], v[64:79]
    v_mfma_f32_32x32x16_bf16 v[80:95], v[96:99], v[108:111], v[80:95]
    v_mfma_f32_32x32x16_bf16 v[80:95], v[100:103], v[108:111], v[80:95]
    ds_read2_b32 v[96:97], v6 offset0:0 offset1:1
    ds_read2_b32 v[98:99], v6 offset0:2 offset1:3
    ds_read2_b32 v[100:101], v8 offset0:0 offset1:1
    ds_read2_b32 v[102:103], v8 offset0:2 offset1:3
    ds_read_b128 v[104:107], v9 offset:320
    ds_read_b128 v[108:111], v10 offset:320
    s_waitcnt lgkmcnt(6)
    v_mfma_f32_32x32x16_bf16 v[64:79], v[112:115], v[120:123], v[64:79]
    v_mfma_f32_32x32x16_bf16 v[64:79], v[116:119], v[120:123], v[64:79]
    v_mfma_f32_32x32x16_bf16 v[80:95], v[112:115], v[124:127], v[80:95]
    v_mfma_f32_32x32x16_bf16 v[80:95], v[116:119], v[124:127], v[80:95]
    ds_read2_b32 v[112:113], v6 offset0:8 offset1:9
    ds_read2_b32 v[114:115], v6 offset0:10 offset1:11
    ds_read2_b32 v[116:117], v8 offset0:8 offset1:9
    ds_read2_b32 v[118:119], v8 offset0:10 offset1:11
    ds_read_b128 v[120:123], v9 offset:352
    ds_read_b128 v[124:127], v10 offset:352
    v_add_u32 v6, 256, v6
    v_add_u32 v8, 256, v8
    s_waitcnt lgkmcnt(6)
    v_mfma_f32_32x32x16_bf16 v[64:79], v[96:99], v[104:107], v[64:79]
    v_mfma_f32_32x32x16_bf16 v[64:79], v[100:103], v[104:107], v[64:79]
    v_mfma_f32_32x32x16_bf16 v[80:95], v[96:99], v[108:111], v[80:95]
    v_mfma_f32_32x32x16_bf16 v[80:95], v[100:103], v[108:111], v[80:95]
    ds_read2_b32 v[96:97], v6 offset0:0 offset1:1
    ds_read2_b32 v[98:99], v6 offset0:2 offset1:3
    ds_read2_b32 v[100:101], v8 offset0:0 offset1:1
    ds_read2_b32 v[102:103], v8 offset0:2 offset1:3
    ds_read_b128 v[104:107], v9 offset:640
    ds_read_b128 v[108:111], v10 offset:640
    s_waitcnt lgkmcnt(6)
    v_mfma_f32_32x32x16_bf16 v[64:79], v[112:115], v[120:123], v[64:79]
    v_mfma_f32_32x32x16_bf16 v[64:79], v[116:119], v[120:123], v[64:79]
    v_mfma_f32_32x32x16_bf16 v[80:95], v[112:115], v[124:127], v[80:95]
    v_mfma_f32_32x32x16_bf16 v[80:95], v[116:119], v[124:127], v[80:95]
    ds_read2_b32 v[112:113], v6 offset0:8 offset1:9
    ds_read2_b32 v[114:115], v6 offset0:10 offset1:11
    ds_read2_b32 v[116:117], v8 offset0:8 offset1:9
    ds_read2_b32 v[118:119], v8 offset0:10 offset1:11
    ds_read_b128 v[120:123], v9 offset:672
    ds_read_b128 v[124:127], v10 offset:672
    v_add_u32 v6, 256, v6
    v_add_u32 v8, 256, v8
    s_waitcnt lgkmcnt(6)
    v_mfma_f32_32x32x16_bf16 v[64:79], v[96:99], v[104:107], v[64:79]
    v_mfma_f32_32x32x16_bf16 v[64:79], v[100:103], v[104:107], v[64:79]
    v_mfma_f32_32x32x16_bf16 v[80:95], v[96:99], v[108:111], v[80:95]
    v_mfma_f32_32x32x16_bf16 v[80:95], v[100:103], v[108:111], v[80:95]
    ds_read2_b32 v[96:97], v6 offset0:0 offset1:1
    ds_read2_b32 v[98:99], v6 offset0:2 offset1:3
    ds_read2_b32 v[100:101], v8 offset0:0 offset1:1
    ds_read2_b32 v[102:103], v8 offset0:2 offset1:3
    ds_read_b128 v[104:107], v9 offset:960
    ds_read_b128 v[108:111], v10 offset:960
    s_waitcnt lgkmcnt(6)
    v_mfma_f32_32x32x16_bf16 v[64:79], v[112:115], v[120:123], v[64:79]
    v_mfma_f32_32x32x16_bf16 v[64:79], v[116:119], v[120:123], v[64:79]
    v_mfma_f32_32x32x16_bf16 v[80:95], v[112:115], v[124:127], v[80:95]
    v_mfma_f32_32x32x16_bf16 v[80:95], v[116:119], v[124:127], v[80:95]
    ds_read2_b32 v[112:113], v6 offset0:8 offset1:9
    ds_read2_b32 v[114:115], v6 offset0:10 offset1:11
    ds_read2_b32 v[116:117], v8 offset0:8 offset1:9
    ds_read2_b32 v[118:119], v8 offset0:10 offset1:11
    ds_read_b128 v[120:123], v9 offset:992
    ds_read_b128 v[124:127], v10 offset:992
    v_add_u32 v6, 256, v6
    v_add_u32 v8, 256, v8
    s_waitcnt lgkmcnt(6)
    v_mfma_f32_32x32x16_bf16 v[64:79], v[96:99], v[104:107], v[64:79]
    v_mfma_f32_32x32x16_bf16 v[64:79], v[100:103], v[104:107], v[64:79]
    v_mfma_f32_32x32x16_bf16 v[80:95], v[96:99], v[108:111], v[80:95]
    v_mfma_f32_32x32x16_bf16 v[80:95], v[100:103], v[108:111], v[80:95]
    ds_read2_b32 v[96:97], v6 offset0:0 offset1:1
    ds_read2_b32 v[98:99], v6 offset0:2 offset1:3
    ds_read2_b32 v[100:101], v8 offset0:0 offset1:1
    ds_read2_b32 v[102:103], v8 offset0:2 offset1:3
    ds_read_b128 v[104:107], v9 offset:1280
    ds_read_b128 v[108:111], v10 offset:1280
    s_waitcnt lgkmcnt(6)
    v_mfma_f32_32x32x16_bf16 v[64:79], v[112:115], v[120:123], v[64:79]
    v_mfma_f32_32x32x16_bf16 v[64:79], v[116:119], v[120:123], v[64:79]
    v_mfma_f32_32x32x16_bf16 v[80:95], v[112:115], v[124:127], v[80:95]
    v_mfma_f32_32x32x16_bf16 v[80:95], v[116:119], v[124:127], v[80:95]
    ds_read2_b32 v[112:113], v6 offset0:8 offset1:9
    ds_read2_b32 v[114:115], v6 offset0:10 offset1:11
    ds_read2_b32 v[116:117], v8 offset0:8 offset1:9
    ds_read2_b32 v[118:119], v8 offset0:10 offset1:11
    ds_read_b128 v[120:123], v9 offset:1312
    ds_read_b128 v[124:127], v10 offset:1312
    v_add_u32 v6, 256, v6
    v_add_u32 v8, 256, v8
    s_waitcnt lgkmcnt(6)
    v_mfma_f32_32x32x16_bf16 v[64:79], v[96:99], v[104:107], v[64:79]
    v_mfma_f32_32x32x16_bf16 v[64:79], v[100:103], v[104:107], v[64:79]
    v_mfma_f32_32x32x16_bf16 v[80:95], v[96:99], v[108:111], v[80:95]
    v_mfma_f32_32x32x16_bf16 v[80:95], v[100:103], v[108:111], v[80:95]
    ds_read2_b32 v[96:97], v6 offset0:0 offset1:1
    ds_read2_b32 v[98:99], v6 offset0:2 offset1:3
    ds_read2_b32 v[100:101], v8 offset0:0 offset1:1
    ds_read2_b32 v[102:103], v8 offset0:2 offset1:3
    ds_read_b128 v[104:107], v9 offset:1600
    ds_read_b128 v[108:111], v10 offset:1600
    s_waitcnt lgkmcnt(6)
    v_mfma_f32_32x32x16_bf16 v[64:79], v[112:115], v[120:123], v[64:79]
    v_mfma_f32_32x32x16_bf16 v[64:79], v[116:119], v[120:123], v[64:79]
    v_mfma_f32_32x32x16_bf16 v[80:95], v[112:115], v[124:127], v[80:95]
    v_mfma_f32_32x32x16_bf16 v[80:95], v[116:119], v[124:127], v[80:95]
    ds_read2_b32 v[112:113], v6 offset0:8 offset1:9
    ds_read2_b32 v[114:115], v6 offset0:10 offset1:11
    ds_read2_b32 v[116:117], v8 offset0:8 offset1:9
    ds_read2_b32 v[118:119], v8 offset0:10 offset1:11
    ds_read_b128 v[120:123], v9 offset:1632
    ds_read_b128 v[124:127], v10 offset:1632
    v_add_u32 v6, 256, v6
    v_add_u32 v8, 256, v8
    s_waitcnt lgkmcnt(6)
    v_mfma_f32_32x32x16_bf16 v[64:79], v[96:99], v[104:107], v[64:79]
    v_mfma_f32_32x32x16_bf16 v[64:79], v[100:103], v[104:107], v[64:79]
    v_mfma_f32_32x32x16_bf16 v[80:95], v[96:99], v[108:111], v[80:95]
    v_mfma_f32_32x32x16_bf16 v[80:95], v[100:103], v[108:111], v[80:95]
    ds_read2_b32 v[96:97], v6 offset0:0 offset1:1
    ds_read2_b32 v[98:99], v6 offset0:2 offset1:3
    ds_read2_b32 v[100:101], v8 offset0:0 offset1:1
    ds_read2_b32 v[102:103], v8 offset0:2 offset1:3
    ds_read_b128 v[104:107], v9 offset:1920
    ds_read_b128 v[108:111], v10 offset:1920
    s_waitcnt lgkmcnt(6)
    v_mfma_f32_32x32x16_bf16 v[64:79], v[112:115], v[120:123], v[64:79]
    v_mfma_f32_32x32x16_bf16 v[64:79], v[116:119], v[120:123], v[64:79]
    v_mfma_f32_32x32x16_bf16 v[80:95], v[112:115], v[124:127], v[80:95]
    v_mfma_f32_32x32x16_bf16 v[80:95], v[116:119], v[124:127], v[80:95]
    ds_read2_b32 v[112:113], v6 offset0:8 offset1:9
    ds_read2_b32 v[114:115], v6 offset0:10 offset1:11
    ds_read2_b32 v[116:117], v8 offset0:8 offset1:9
    ds_read2_b32 v[118:119], v8 offset0:10 offset1:11
    ds_read_b128 v[120:123], v9 offset:1952
    ds_read_b128 v[124:127], v10 offset:1952
    v_add_u32 v6, 256, v6
    v_add_u32 v8, 256, v8
    s_waitcnt lgkmcnt(6)
    v_mfma_f32_32x32x16_bf16 v[64:79], v[96:99], v[104:107], v[64:79]
    v_mfma_f32_32x32x16_bf16 v[64:79], v[100:103], v[104:107], v[64:79]
    v_mfma_f32_32x32x16_bf16 v[80:95], v[96:99], v[108:111], v[80:95]
    v_mfma_f32_32x32x16_bf16 v[80:95], v[100:103], v[108:111], v[80:95]
    ds_read2_b32 v[96:97], v6 offset0:0 offset1:1
    ds_read2_b32 v[98:99], v6 offset0:2 offset1:3
    ds_read2_b32 v[100:101], v8 offset0:0 offset1:1
    ds_read2_b32 v[102:103], v8 offset0:2 offset1:3
    ds_read_b128 v[104:107], v9 offset:2240
    ds_read_b128 v[108:111], v10 offset:2240
    s_waitcnt lgkmcnt(6)
    v_mfma_f32_32x32x16_bf16 v[64:79], v[112:115], v[120:123], v[64:79]
    v_mfma_f32_32x32x16_bf16 v[64:79], v[116:119], v[120:123], v[64:79]
    v_mfma_f32_32x32x16_bf16 v[80:95], v[112:115], v[124:127], v[80:95]
    v_mfma_f32_32x32x16_bf16 v[80:95], v[116:119], v[124:127], v[80:95]
    ds_read2_b32 v[112:113], v6 offset0:8 offset1:9
    ds_read2_b32 v[114:115], v6 offset0:10 offset1:11
    ds_read2_b32 v[116:117], v8 offset0:8 offset1:9
    ds_read2_b32 v[118:119], v8 offset0:10 offset1:11
    ds_read_b128 v[120:123], v9 offset:2272
    ds_read_b128 v[124:127], v10 offset:2272
    v_add_u32 v6, 256, v6
    v_add_u32 v8, 256, v8
    s_waitcnt lgkmcnt(6)
    v_mfma_f32_32x32x16_bf16 v[64:79], v[96:99], v[104:107], v[64:79]
    v_mfma_f32_32x32x16_bf16 v[64:79], v[100:103], v[104:107], v[64:79]
    v_mfma_f32_32x32x16_bf16 v[80:95], v[96:99], v[108:111], v[80:95]
    v_mfma_f32_32x32x16_bf16 v[80:95], v[100:103], v[108:111], v[80:95]
    ds_read2_b32 v[96:97], v6 offset0:0 offset1:1
    ds_read2_b32 v[98:99], v6 offset0:2 offset1:3
    ds_read2_b32 v[100:101], v8 offset0:0 offset1:1
    ds_read2_b32 v[102:103], v8 offset0:2 offset1:3
    ds_read_b128 v[104:107], v9 offset:2560
    s_waitcnt lgkmcnt(5)
    v_mfma_f32_32x32x16_bf16 v[64:79], v[112:115], v[120:123], v[64:79]
    v_mfma_f32_32x32x16_bf16 v[64:79], v[116:119], v[120:123], v[64:79]
    v_mfma_f32_32x32x16_bf16 v[80:95], v[112:115], v[124:127], v[80:95]
    v_mfma_f32_32x32x16_bf16 v[80:95], v[116:119], v[124:127], v[80:95]
    ds_read2_b32 v[112:113], v6 offset0:8 offset1:9
    ds_read2_b32 v[114:115], v6 offset0:10 offset1:11
    ds_read2_b32 v[116:117], v8 offset0:8 offset1:9
    ds_read2_b32 v[118:119], v8 offset0:10 offset1:11
    ds_read_b128 v[120:123], v9 offset:2592
    v_add_u32 v6, 256, v6
    v_add_u32 v8, 256, v8
    s_waitcnt lgkmcnt(5)
    v_mfma_f32_32x32x16_bf16 v[64:79], v[96:99], v[104:107], v[64:79]
    v_mfma_f32_32x32x16_bf16 v[64:79], v[100:103], v[104:107], v[64:79]
    ds_read2_b32 v[96:97], v6 offset0:0 offset1:1
    ds_read2_b32 v[98:99], v6 offset0:2 offset1:3
    ds_read2_b32 v[100:101], v8 offset0:0 offset1:1
    ds_read2_b32 v[102:103], v8 offset0:2 offset1:3
    ds_read_b128 v[104:107], v9 offset:2880
    s_waitcnt lgkmcnt(5)
    v_mfma_f32_32x32x16_bf16 v[64:79], v[112:115], v[120:123], v[64:79]
    v_mfma_f32_32x32x16_bf16 v[64:79], v[116:119], v[120:123], v[64:79]
    ds_read2_b32 v[112:113], v6 offset0:8 offset1:9
    ds_read2_b32 v[114:115], v6 offset0:10 offset1:11
    ds_read2_b32 v[116:117], v8 offset0:8 offset1:9
    ds_read2_b32 v[118:119], v8 offset0:10 offset1:11
    ds_read_b128 v[120:123], v9 offset:2912
    v_add_u32 v6, 256, v6
    v_add_u32 v8, 256, v8
    s_waitcnt lgkmcnt(5)
    v_mfma_f32_32x32x16_bf16 v[64:79], v[96:99], v[104:107], v[64:79]
    v_mfma_f32_32x32x16_bf16 v[64:79], v[100:103], v[104:107], v[64:79]
    ds_read2_b32 v[96:97], v6 offset0:0 offset1:1
    ds_read2_b32 v[98:99], v6 offset0:2 offset1:3
    ds_read2_b32 v[100:101], v8 offset0:0 offset1:1
    ds_read2_b32 v[102:103], v8 offset0:2 offset1:3
    ds_read_b128 v[104:107], v9 offset:3200
    s_waitcnt lgkmcnt(5)
    v_mfma_f32_32x32x16_bf16 v[64:79], v[112:115], v[120:123], v[64:79]
    v_mfma_f32_32x32x16_bf16 v[64:79], v[116:119], v[120:123], v[64:79]
    ds_read2_b32 v[112:113], v6 offset0:8 offset1:9
    ds_read2_b32 v[114:115], v6 offset0:10 offset1:11
    ds_read2_b32 v[116:117], v8 offset0:8 offset1:9
    ds_read2_b32 v[118:119], v8 offset0:10 offset1:11
    ds_read_b128 v[120:123], v9 offset:3232
    v_add_u32 v6, 256, v6
    v_add_u32 v8, 256, v8
    s_waitcnt lgkmcnt(5)
    v_mfma_f32_32x32x16_bf16 v[64:79], v[96:99], v[104:107], v[64:79]
    v_mfma_f32_32x32x16_bf16 v[64:79], v[100:103], v[104:107], v[64:79]
    ds_read2_b32 v[96:97], v6 offset0:0 offset1:1
    ds_read2_b32 v[98:99], v6 offset0:2 offset1:3
    ds_read2_b32 v[100:101], v8 offset0:0 offset1:1
    ds_read2_b32 v[102:103], v8 offset0:2 offset1:3
    ds_read_b128 v[104:107], v9 offset:3520
    s_waitcnt lgkmcnt(5)
    v_mfma_f32_32x32x16_bf16 v[64:79], v[112:115], v[120:123], v[64:79]
    v_mfma_f32_32x32x16_bf16 v[64:79], v[116:119], v[120:123], v[64:79]
    ds_read2_b32 v[112:113], v6 offset0:8 offset1:9
    ds_read2_b32 v[114:115], v6 offset0:10 offset1:11
    ds_read2_b32 v[116:117], v8 offset0:8 offset1:9
    ds_read2_b32 v[118:119], v8 offset0:10 offset1:11
    ds_read_b128 v[120:123], v9 offset:3552
    v_add_u32 v6, 256, v6
    v_add_u32 v8, 256, v8
    s_waitcnt lgkmcnt(5)
    v_mfma_f32_32x32x16_bf16 v[64:79], v[96:99], v[104:107], v[64:79]
    v_mfma_f32_32x32x16_bf16 v[64:79], v[100:103], v[104:107], v[64:79]
    ds_read2_b32 v[96:97], v6 offset0:0 offset1:1
    ds_read2_b32 v[98:99], v6 offset0:2 offset1:3
    ds_read2_b32 v[100:101], v8 offset0:0 offset1:1
    ds_read2_b32 v[102:103], v8 offset0:2 offset1:3
    ds_read_b128 v[104:107], v9 offset:3840
    s_waitcnt lgkmcnt(5)
    v_mfma_f32_32x32x16_bf16 v[64:79], v[112:115], v[120:123], v[64:79]
    v_mfma_f32_32x32x16_bf16 v[64:79], v[116:119], v[120:123], v[64:79]
    ds_read2_b32 v[112:113], v6 offset0:8 offset1:9
    ds_read2_b32 v[114:115], v6 offset0:10 offset1:11
    ds_read2_b32 v[116:117], v8 offset0:8 offset1:9
    ds_read2_b32 v[118:119], v8 offset0:10 offset1:11
    ds_read_b128 v[120:123], v9 offset:3872
    v_add_u32 v6, 256, v6
    v_add_u32 v8, 256, v8
    s_waitcnt lgkmcnt(5)
    v_mfma_f32_32x32x16_bf16 v[64:79], v[96:99], v[104:107], v[64:79]
    v_mfma_f32_32x32x16_bf16 v[64:79], v[100:103], v[104:107], v[64:79]
    ds_read2_b32 v[96:97], v6 offset0:0 offset1:1
    ds_read2_b32 v[98:99], v6 offset0:2 offset1:3
    ds_read2_b32 v[100:101], v8 offset0:0 offset1:1
    ds_read2_b32 v[102:103], v8 offset0:2 offset1:3
    ds_read_b128 v[104:107], v9 offset:4160
    s_waitcnt lgkmcnt(5)
    v_mfma_f32_32x32x16_bf16 v[64:79], v[112:115], v[120:123], v[64:79]
    v_mfma_f32_32x32x16_bf16 v[64:79], v[116:119], v[120:123], v[64:79]
    ds_read2_b32 v[112:113], v6 offset0:8 offset1:9
    ds_read2_b32 v[114:115], v6 offset0:10 offset1:11
    ds_read2_b32 v[116:117], v8 offset0:8 offset1:9
    ds_read2_b32 v[118:119], v8 offset0:10 offset1:11
    ds_read_b128 v[120:123], v9 offset:4192
    v_add_u32 v6, 256, v6
    v_add_u32 v8, 256, v8
    s_waitcnt lgkmcnt(5)
    v_mfma_f32_32x32x16_bf16 v[64:79], v[96:99], v[104:107], v[64:79]
    v_mfma_f32_32x32x16_bf16 v[64:79], v[100:103], v[104:107], v[64:79]
    ds_read2_b32 v[96:97], v6 offset0:0 offset1:1
    ds_read2_b32 v[98:99], v6 offset0:2 offset1:3
    ds_read2_b32 v[100:101], v8 offset0:0 offset1:1
    ds_read2_b32 v[102:103], v8 offset0:2 offset1:3
    ds_read_b128 v[104:107], v9 offset:4480
    s_waitcnt lgkmcnt(5)
    v_mfma_f32_32x32x16_bf16 v[64:79], v[112:115], v[120:123], v[64:79]
    v_mfma_f32_32x32x16_bf16 v[64:79], v[116:119], v[120:123], v[64:79]
    ds_read2_b32 v[112:113], v6 offset0:8 offset1:9
    ds_read2_b32 v[114:115], v6 offset0:10 offset1:11
    ds_read2_b32 v[116:117], v8 offset0:8 offset1:9
    ds_read2_b32 v[118:119], v8 offset0:10 offset1:11
    ds_read_b128 v[120:123], v9 offset:4512
    v_add_u32 v6, 256, v6
    v_add_u32 v8, 256, v8
    s_waitcnt lgkmcnt(5)
    v_mfma_f32_32x32x16_bf16 v[64:79], v[96:99], v[104:107], v[64:79]
    v_mfma_f32_32x32x16_bf16 v[64:79], v[100:103], v[104:107], v[64:79]
    ds_read2_b32 v[96:97], v6 offset0:0 offset1:1
    ds_read2_b32 v[98:99], v6 offset0:2 offset1:3
    ds_read2_b32 v[100:101], v8 offset0:0 offset1:1
    ds_read2_b32 v[102:103], v8 offset0:2 offset1:3
    ds_read_b128 v[104:107], v9 offset:4800
    s_waitcnt lgkmcnt(5)
    v_mfma_f32_32x32x16_bf16 v[64:79], v[112:115], v[120:123], v[64:79]
    v_mfma_f32_32x32x16_bf16 v[64:79], v[116:119], v[120:123], v[64:79]
    ds_read2_b32 v[112:113], v6 offset0:8 offset1:9
    ds_read2_b32 v[114:115], v6 offset0:10 offset1:11
    ds_read2_b32 v[116:117], v8 offset0:8 offset1:9
    ds_read2_b32 v[118:119], v8 offset0:10 offset1:11
    ds_read_b128 v[120:123], v9 offset:4832
    v_add_u32 v6, 256, v6
    v_add_u32 v8, 256, v8
    s_waitcnt lgkmcnt(5)
    v_mfma_f32_32x32x16_bf16 v[64:79], v[96:99], v[104:107], v[64:79]
    v_mfma_f32_32x32x16_bf16 v[64:79], v[100:103], v[104:107], v[64:79]
    s_waitcnt lgkmcnt(0)
    v_mfma_f32_32x32x16_bf16 v[64:79], v[112:115], v[120:123], v[64:79]
    v_mfma_f32_32x32x16_bf16 v[64:79], v[116:119], v[120:123], v[64:79]
    s_nop 15
    s_barrier
    v_mul_u32_u24 v6, 144, v4
    v_add_u32 v6, v6, v7
    v_mul_u32_u24 v8, 9216, v2
    v_add_u32 v6, v6, v8
    ds_write_b128 v6, v[80:83] offset:0
    ds_write_b128 v6, v[84:87] offset:32
    ds_write_b128 v6, v[88:91] offset:64
    ds_write_b128 v6, v[92:95] offset:96
    ds_write_b128 v6, v[64:67] offset:4608
    ds_write_b128 v6, v[68:71] offset:4640
    ds_write_b128 v6, v[72:75] offset:4672
    ds_write_b128 v6, v[76:79] offset:4704
    s_waitcnt lgkmcnt(0)
    s_barrier
    v_lshrrev_b32 v6, 2, v0
    v_mul_u32_u24 v6, 144, v6
    v_and_b32 v7, 3, v0
    v_lshlrev_b32 v7, 5, v7
    v_add_u32 v6, v6, v7
    ds_read_b128 v[96:99], v6 offset:0
    ds_read_b128 v[100:103], v6 offset:16
    ds_read_b128 v[104:107], v6 offset:9216
    ds_read_b128 v[108:111], v6 offset:9232
    ds_read_b128 v[112:115], v6 offset:18432
    ds_read_b128 v[116:119], v6 offset:18448
    ds_read_b128 v[120:123], v6 offset:27648
    ds_read_b128 v[124:127], v6 offset:27664
    s_waitcnt lgkmcnt(0)
    v_add_f32 v96, v96, v104
    v_add_f32 v112, v112, v120
    v_add_f32 v96, v96, v112
    v_add_f32 v97, v97, v105
    v_add_f32 v113, v113, v121
    v_add_f32 v97, v97, v113
    v_add_f32 v98, v98, v106
    v_add_f32 v114, v114, v122
    v_add_f32 v98, v98, v114
    v_add_f32 v99, v99, v107
    v_add_f32 v115, v115, v123
    v_add_f32 v99, v99, v115
    v_add_f32 v100, v100, v108
    v_add_f32 v116, v116, v124
    v_add_f32 v100, v100, v116
    v_add_f32 v101, v101, v109
    v_add_f32 v117, v117, v125
    v_add_f32 v101, v101, v117
    v_add_f32 v102, v102, v110
    v_add_f32 v118, v118, v126
    v_add_f32 v102, v102, v118
    v_add_f32 v103, v103, v111
    v_add_f32 v119, v119, v127
    v_add_f32 v103, v103, v119
    v_lshlrev_b32 v164, 16, v164
    v_cvt_pk_bf16_f32 v16, v96, v97
    v_lshlrev_b32 v17, 16, v16
    v_and_b32 v18, 0xffff0000, v16
    v_lshlrev_b32 v19, 16, v160
    v_and_b32 v20, 0xffff0000, v160
    v_mul_f32 v19, v19, v164
    v_mul_f32 v20, v20, v164
    v_cvt_pk_bf16_f32 v21, v19, v20
    v_lshlrev_b32 v19, 16, v21
    v_and_b32 v20, 0xffff0000, v21
    v_add_f32 v17, v17, v19
    v_add_f32 v18, v18, v20
    v_cvt_pk_bf16_f32 v24, v17, v18
    v_cvt_pk_bf16_f32 v16, v98, v99
    v_lshlrev_b32 v17, 16, v16
    v_and_b32 v18, 0xffff0000, v16
    v_lshlrev_b32 v19, 16, v161
    v_and_b32 v20, 0xffff0000, v161
    v_mul_f32 v19, v19, v164
    v_mul_f32 v20, v20, v164
    v_cvt_pk_bf16_f32 v21, v19, v20
    v_lshlrev_b32 v19, 16, v21
    v_and_b32 v20, 0xffff0000, v21
    v_add_f32 v17, v17, v19
    v_add_f32 v18, v18, v20
    v_cvt_pk_bf16_f32 v25, v17, v18
    v_cvt_pk_bf16_f32 v16, v100, v101
    v_lshlrev_b32 v17, 16, v16
    v_and_b32 v18, 0xffff0000, v16
    v_lshlrev_b32 v19, 16, v162
    v_and_b32 v20, 0xffff0000, v162
    v_mul_f32 v19, v19, v164
    v_mul_f32 v20, v20, v164
    v_cvt_pk_bf16_f32 v21, v19, v20
    v_lshlrev_b32 v19, 16, v21
    v_and_b32 v20, 0xffff0000, v21
    v_add_f32 v17, v17, v19
    v_add_f32 v18, v18, v20
    v_cvt_pk_bf16_f32 v26, v17, v18
    v_cvt_pk_bf16_f32 v16, v102, v103
    v_lshlrev_b32 v17, 16, v16
    v_and_b32 v18, 0xffff0000, v16
    v_lshlrev_b32 v19, 16, v163
    v_and_b32 v20, 0xffff0000, v163
    v_mul_f32 v19, v19, v164
    v_mul_f32 v20, v20, v164
    v_cvt_pk_bf16_f32 v21, v19, v20
    v_lshlrev_b32 v19, 16, v21
    v_and_b32 v20, 0xffff0000, v21
    v_add_f32 v17, v17, v19
    v_add_f32 v18, v18, v20
    v_cvt_pk_bf16_f32 v27, v17, v18
    buffer_store_dwordx4 v[24:27], v165, s[52:55], s18 offen
L_kc_end:
    s_endpgm
.globl k3_ln2_kernel
.p2align 8
.type k3_ln2_kernel,@function
k3_ln2_kernel:
    s_cmp_ge_u32 s2, 256
    s_cbranch_scc1 L_k3_end
    s_load_dwordx2 s[4:5], s[0:1], 0
    s_load_dwordx2 s[6:7], s[0:1], 112
    v_and_b32 v1, 63, v0
    v_lshrrev_b32 v2, 6, v0
    s_mul_i32 s16, s2, 10240
    s_lshl_b32 s17, s2, 4
    s_waitcnt lgkmcnt(0)
    s_mov_b32 s8, s4
    s_mov_b32 s9, s5
    s_mov_b32 s10, 2621440
    s_mov_b32 s11, 0x00020000
    s_add_u32 s12, s6, 2621440
    s_addc_u32 s13, s7, 0
    s_mov_b32 s14, 2621440
    s_mov_b32 s15, 0x00020000
    s_add_u32 s20, s6, 5242880
    s_addc_u32 s21, s7, 0
    s_mov_b32 s22, 2621440
    s_mov_b32 s23, 0x00020000
    s_add_u32 s24, s6, 7864320
    s_addc_u32 s25, s7, 0
    s_mov_b32 s26, 2621440
    s_mov_b32 s27, 0x00020000
    v_mul_u32_u24 v5, 20, v0
    v_lshlrev_b32 v7, 4, v0
    buffer_load_dwordx4 v[56:59], v7, s[12:15], s16 offen
    v_add_u32 v7, 4096, v7
    buffer_load_dwordx4 v[60:63], v7, s[12:15], s16 offen
    v_add_u32 v7, 4096, v7
    buffer_load_dwordx4 v[64:67], v7, s[12:15], s16 offen
    v_lshlrev_b32 v3, 2, v1
    v_mul_u32_u24 v11, 2560, v2
    v_add_u32 v3, v3, v11
    buffer_load_dword v16, v3, s[8:11], s16 offen offset:0
    buffer_load_dword v17, v3, s[8:11], s16 offen offset:256
    buffer_load_dword v18, v3, s[8:11], s16 offen offset:512
    buffer_load_dword v19, v3, s[8:11], s16 offen offset:768
    buffer_load_dword v20, v3, s[8:11], s16 offen offset:1024
    buffer_load_dword v21, v3, s[8:11], s16 offen offset:1280
    buffer_load_dword v22, v3, s[8:11], s16 offen offset:1536
    buffer_load_dword v23, v3, s[8:11], s16 offen offset:1792
    buffer_load_dword v24, v3, s[8:11], s16 offen offset:2048
    buffer_load_dword v25, v3, s[8:11], s16 offen offset:2304
    s_waitcnt vmcnt(10)
    ds_write2_b32 v5, v56, v57 offset0:0 offset1:1
    ds_write2_b32 v5, v58, v59 offset0:2 offset1:3
    v_add_u32 v5, 5120, v5
    ds_write2_b32 v5, v60, v61 offset0:0 offset1:1
    ds_write2_b32 v5, v62, v63 offset0:2 offset1:3
    v_add_u32 v5, 5120, v5
    v_cmp_gt_u32 vcc, 128, v0
    s_nop 1
    s_and_saveexec_b64 s[18:19], vcc
    ds_write2_b32 v5, v64, v65 offset0:0 offset1:1
    ds_write2_b32 v5, v66, v67 offset0:2 offset1:3
    s_mov_b64 exec, s[18:19]
    s_waitcnt lgkmcnt(0)
    s_barrier
    v_mul_u32_u24 v12, 40, v1
    v_lshlrev_b32 v13, 2, v2
    v_add_u32 v12, v12, v13
    ds_read_b32 v100, v12 offset:0
    ds_read_b32 v101, v12 offset:20
    ds_read_b32 v102, v12 offset:2560
    ds_read_b32 v103, v12 offset:2580
    ds_read_b32 v104, v12 offset:5120
    ds_read_b32 v105, v12 offset:5140
    ds_read_b32 v106, v12 offset:7680
    ds_read_b32 v107, v12 offset:7700
    ds_read_b32 v108, v12 offset:10240
    ds_read_b32 v109, v12 offset:10260
    s_waitcnt vmcnt(0) lgkmcnt(0)
    v_lshlrev_b32 v30, 16, v16
    v_lshlrev_b32 v110, 16, v100
    v_add_f32 v30, v30, v110
    v_and_b32 v31, 0xffff0000, v16
    v_lshlrev_b32 v110, 16, v101
    v_add_f32 v31, v31, v110
    v_lshlrev_b32 v32, 16, v17
    v_lshlrev_b32 v110, 16, v102
    v_add_f32 v32, v32, v110
    v_and_b32 v33, 0xffff0000, v17
    v_lshlrev_b32 v110, 16, v103
    v_add_f32 v33, v33, v110
    v_lshlrev_b32 v34, 16, v18
    v_lshlrev_b32 v110, 16, v104
    v_add_f32 v34, v34, v110
    v_and_b32 v35, 0xffff0000, v18
    v_lshlrev_b32 v110, 16, v105
    v_add_f32 v35, v35, v110
    v_lshlrev_b32 v36, 16, v19
    v_lshlrev_b32 v110, 16, v106
    v_add_f32 v36, v36, v110
    v_and_b32 v37, 0xffff0000, v19
    v_lshlrev_b32 v110, 16, v107
    v_add_f32 v37, v37, v110
    v_lshlrev_b32 v38, 16, v20
    v_lshlrev_b32 v110, 16, v108
    v_add_f32 v38, v38, v110
    v_and_b32 v39, 0xffff0000, v20
    v_lshlrev_b32 v110, 16, v109
    v_add_f32 v39, v39, v110
    v_cvt_pk_bf16_f32 v110, v30, v31
    buffer_store_dword v110, v3, s[20:23], s16 offen offset:0
    v_lshlrev_b32 v30, 16, v110
    v_and_b32 v31, 0xffff0000, v110
    v_cvt_pk_bf16_f32 v110, v32, v33
    buffer_store_dword v110, v3, s[20:23], s16 offen offset:256
    v_lshlrev_b32 v32, 16, v110
    v_and_b32 v33, 0xffff0000, v110
    v_cvt_pk_bf16_f32 v110, v34, v35
    buffer_store_dword v110, v3, s[20:23], s16 offen offset:512
    v_lshlrev_b32 v34, 16, v110
    v_and_b32 v35, 0xffff0000, v110
    v_cvt_pk_bf16_f32 v110, v36, v37
    buffer_store_dword v110, v3, s[20:23], s16 offen offset:768
    v_lshlrev_b32 v36, 16, v110
    v_and_b32 v37, 0xffff0000, v110
    v_cvt_pk_bf16_f32 v110, v38, v39
    buffer_store_dword v110, v3, s[20:23], s16 offen offset:1024
    v_lshlrev_b32 v38, 16, v110
    v_and_b32 v39, 0xffff0000, v110
    v_lshlrev_b32 v40, 16, v21
    v_and_b32 v110, 0xffff0000, v100
    v_add_f32 v40, v40, v110
    v_and_b32 v41, 0xffff0000, v21
    v_and_b32 v110, 0xffff0000, v101
    v_add_f32 v41, v41, v110
    v_lshlrev_b32 v42, 16, v22
    v_and_b32 v110, 0xffff0000, v102
    v_add_f32 v42, v42, v110
    v_and_b32 v43, 0xffff0000, v22
    v_and_b32 v110, 0xffff0000, v103
    v_add_f32 v43, v43, v110
    v_lshlrev_b32 v44, 16, v23
    v_and_b32 v110, 0xffff0000, v104
    v_add_f32 v44, v44, v110
    v_and_b32 v45, 0xffff0000, v23
    v_and_b32 v110, 0xffff0000, v105
    v_add_f32 v45, v45, v110
    v_lshlrev_b32 v46, 16, v24
    v_and_b32 v110, 0xffff0000, v106
    v_add_f32 v46, v46, v110
    v_and_b32 v47, 0xffff0000, v24
    v_and_b32 v110, 0xffff0000, v107
    v_add_f32 v47, v47, v110
    v_lshlrev_b32 v48, 16, v25
    v_and_b32 v110, 0xffff0000, v108
    v_add_f32 v48, v48, v110
    v_and_b32 v49, 0xffff0000, v25
    v_and_b32 v110, 0xffff0000, v109
    v_add_f32 v49, v49, v110
    v_cvt_pk_bf16_f32 v110, v40, v41
    buffer_store_dword v110, v3, s[20:23], s16 offen offset:1280
    v_lshlrev_b32 v40, 16, v110
    v_and_b32 v41, 0xffff0000, v110
    v_cvt_pk_bf16_f32 v110, v42, v43
    buffer_store_dword v110, v3, s[20:23], s16 offen offset:1536
    v_lshlrev_b32 v42, 16, v110
    v_and_b32 v43, 0xffff0000, v110
    v_cvt_pk_bf16_f32 v110, v44, v45
    buffer_store_dword v110, v3, s[20:23], s16 offen offset:1792
    v_lshlrev_b32 v44, 16, v110
    v_and_b32 v45, 0xffff0000, v110
    v_cvt_pk_bf16_f32 v110, v46, v47
    buffer_store_dword v110, v3, s[20:23], s16 offen offset:2048
    v_lshlrev_b32 v46, 16, v110
    v_and_b32 v47, 0xffff0000, v110
    v_cvt_pk_bf16_f32 v110, v48, v49
    buffer_store_dword v110, v3, s[20:23], s16 offen offset:2304
    v_lshlrev_b32 v48, 16, v110
    v_and_b32 v49, 0xffff0000, v110
    v_add_f32 v70, v30, v31
    v_add_f32 v75, v40, v41
    v_add_f32 v70, v70, v32
    v_add_f32 v75, v75, v42
    v_add_f32 v70, v70, v33
    v_add_f32 v75, v75, v43
    v_add_f32 v70, v70, v34
    v_add_f32 v75, v75, v44
    v_add_f32 v70, v70, v35
    v_add_f32 v75, v75, v45
    v_add_f32 v70, v70, v36
    v_add_f32 v75, v75, v46
    v_add_f32 v70, v70, v37
    v_add_f32 v75, v75, v47
    v_add_f32 v70, v70, v38
    v_add_f32 v75, v75, v48
    v_add_f32 v70, v70, v39
    v_add_f32 v75, v75, v49
    s_nop 0
    v_add_f32_dpp v70, v70, v70 quad_perm:[1,0,3,2] row_mask:0xf bank_mask:0xf
    v_add_f32_dpp v75, v75, v75 quad_perm:[1,0,3,2] row_mask:0xf bank_mask:0xf
    s_nop 0
    v_add_f32_dpp v70, v70, v70 quad_perm:[2,3,0,1] row_mask:0xf bank_mask:0xf
    v_add_f32_dpp v75, v75, v75 quad_perm:[2,3,0,1] row_mask:0xf bank_mask:0xf
    s_nop 0
    v_add_f32_dpp v70, v70, v70 row_half_mirror row_mask:0xf bank_mask:0xf
    v_add_f32_dpp v75, v75, v75 row_half_mirror row_mask:0xf bank_mask:0xf
    s_nop 0
    v_add_f32_dpp v70, v70, v70 row_mirror row_mask:0xf bank_mask:0xf
    v_add_f32_dpp v75, v75, v75 row_mirror row_mask:0xf bank_mask:0xf
    s_nop 0
    v_add_f32_dpp v70, v70, v70 row_bcast:15 row_mask:0xa bank_mask:0xf
    v_add_f32_dpp v75, v75, v75 row_bcast:15 row_mask:0xa bank_mask:0xf
    s_nop 0
    v_add_f32_dpp v70, v70, v70 row_bcast:31 row_mask:0xc bank_mask:0xf
    v_add_f32_dpp v75, v75, v75 row_bcast:31 row_mask:0xc bank_mask:0xf
    s_nop 0
    v_readlane_b32 s28, v70, 63
    v_readlane_b32 s29, v75, 63
    s_nop 1
    v_mov_b32 v71, s28
    v_mov_b32 v76, s29
    v_mul_f32 v71, 0x3acccccd, v71
    v_mul_f32 v76, 0x3acccccd, v76
    v_sub_f32 v72, v30, v71
    v_sub_f32 v77, v40, v76
    v_mul_f32 v70, v72, v72
    v_mul_f32 v75, v77, v77
    v_sub_f32 v72, v31, v71
    v_sub_f32 v77, v41, v76
    v_fmac_f32 v70, v72, v72
    v_fmac_f32 v75, v77, v77
    v_sub_f32 v72, v32, v71
    v_sub_f32 v77, v42, v76
    v_fmac_f32 v70, v72, v72
    v_fmac_f32 v75, v77, v77
    v_sub_f32 v72, v33, v71
    v_sub_f32 v77, v43, v76
    v_fmac_f32 v70, v72, v72
    v_fmac_f32 v75, v77, v77
    v_sub_f32 v72, v34, v71
    v_sub_f32 v77, v44, v76
    v_fmac_f32 v70, v72, v72
    v_fmac_f32 v75, v77, v77
    v_sub_f32 v72, v35, v71
    v_sub_f32 v77, v45, v76
    v_fmac_f32 v70, v72, v72
    v_fmac_f32 v75, v77, v77
    v_sub_f32 v72, v36, v71
    v_sub_f32 v77, v46, v76
    v_fmac_f32 v70, v72, v72
    v_fmac_f32 v75, v77, v77
    v_sub_f32 v72, v37, v71
    v_sub_f32 v77, v47, v76
    v_fmac_f32 v70, v72, v72
    v_fmac_f32 v75, v77, v77
    v_sub_f32 v72, v38, v71
    v_sub_f32 v77, v48, v76
    v_fmac_f32 v70, v72, v72
    v_fmac_f32 v75, v77, v77
    v_sub_f32 v72, v39, v71
    v_sub_f32 v77, v49, v76
    v_fmac_f32 v70, v72, v72
    v_fmac_f32 v75, v77, v77
    s_nop 0
    v_add_f32_dpp v70, v70, v70 quad_perm:[1,0,3,2] row_mask:0xf bank_mask:0xf
    v_add_f32_dpp v75, v75, v75 quad_perm:[1,0,3,2] row_mask:0xf bank_mask:0xf
    s_nop 0
    v_add_f32_dpp v70, v70, v70 quad_perm:[2,3,0,1] row_mask:0xf bank_mask:0xf
    v_add_f32_dpp v75, v75, v75 quad_perm:[2,3,0,1] row_mask:0xf bank_mask:0xf
    s_nop 0
    v_add_f32_dpp v70, v70, v70 row_half_mirror row_mask:0xf bank_mask:0xf
    v_add_f32_dpp v75, v75, v75 row_half_mirror row_mask:0xf bank_mask:0xf
    s_nop 0
    v_add_f32_dpp v70, v70, v70 row_mirror row_mask:0xf bank_mask:0xf
    v_add_f32_dpp v75, v75, v75 row_mirror row_mask:0xf bank_mask:0xf
    s_nop 0
    v_add_f32_dpp v70, v70, v70 row_bcast:15 row_mask:0xa bank_mask:0xf
    v_add_f32_dpp v75, v75, v75 row_bcast:15 row_mask:0xa bank_mask:0xf
    s_nop 0
    v_add_f32_dpp v70, v70, v70 row_bcast:31 row_mask:0xc bank_mask:0xf
    v_add_f32_dpp v75, v75, v75 row_bcast:31 row_mask:0xc bank_mask:0xf
    s_nop 0
    v_readlane_b32 s28, v70, 63
    v_readlane_b32 s29, v75, 63
    s_nop 1
    v_mov_b32 v72, s28
    v_mov_b32 v77, s29
    v_mul_f32 v72, 0x3acccccd, v72
    v_mul_f32 v77, 0x3acccccd, v77
    v_cvt_pk_bf16_f32 v73, v71, v71
    v_cvt_pk_bf16_f32 v78, v76, v76
    v_lshlrev_b32 v73, 16, v73
    v_lshlrev_b32 v78, 16, v78
    v_cvt_pk_bf16_f32 v74, v72, v72
    v_cvt_pk_bf16_f32 v79, v77, v77
    v_lshlrev_b32 v74, 16, v74
    v_lshlrev_b32 v79, 16, v79
    v_add_f32 v74, 0x3727c5ac, v74
    v_add_f32 v79, 0x3727c5ac, v79
    v_cvt_pk_bf16_f32 v74, v74, v74
    v_cvt_pk_bf16_f32 v79, v79, v79
    v_lshlrev_b32 v74, 16, v74
    v_lshlrev_b32 v79, 16, v79
    v_sqrt_f32 v74, v74
    v_sqrt_f32 v79, v79
    s_nop 0
    v_cvt_pk_bf16_f32 v74, v74, v74
    v_cvt_pk_bf16_f32 v79, v79, v79
    v_lshlrev_b32 v74, 16, v74
    v_lshlrev_b32 v79, 16, v79
    v_rcp_f32 v70, v74
    v_rcp_f32 v75, v79
    s_nop 0
    v_sub_f32 v50, v30, v73
    v_sub_f32 v60, v40, v78
    v_sub_f32 v51, v31, v73
    v_sub_f32 v61, v41, v78
    v_cvt_pk_bf16_f32 v72, v50, v51
    v_cvt_pk_bf16_f32 v77, v60, v61
    v_lshlrev_b32 v50, 16, v72
    v_lshlrev_b32 v60, 16, v77
    v_and_b32 v51, 0xffff0000, v72
    v_and_b32 v61, 0xffff0000, v77
    v_mul_f32 v72, v50, v70
    v_mul_f32 v77, v60, v75
    v_fma_f32 v50, -v72, v74, v50
    v_fma_f32 v60, -v77, v79, v60
    v_fma_f32 v50, v50, v70, v72
    v_fma_f32 v60, v60, v75, v77
    v_mul_f32 v72, v51, v70
    v_mul_f32 v77, v61, v75
    v_fma_f32 v51, -v72, v74, v51
    v_fma_f32 v61, -v77, v79, v61
    v_fma_f32 v51, v51, v70, v72
    v_fma_f32 v61, v61, v75, v77
    v_sub_f32 v52, v32, v73
    v_sub_f32 v62, v42, v78
    v_sub_f32 v53, v33, v73
    v_sub_f32 v63, v43, v78
    v_cvt_pk_bf16_f32 v72, v52, v53
    v_cvt_pk_bf16_f32 v77, v62, v63
    v_lshlrev_b32 v52, 16, v72
    v_lshlrev_b32 v62, 16, v77
    v_and_b32 v53, 0xffff0000, v72
    v_and_b32 v63, 0xffff0000, v77
    v_mul_f32 v72, v52, v70
    v_mul_f32 v77, v62, v75
    v_fma_f32 v52, -v72, v74, v52
    v_fma_f32 v62, -v77, v79, v62
    v_fma_f32 v52, v52, v70, v72
    v_fma_f32 v62, v62, v75, v77
    v_mul_f32 v72, v53, v70
    v_mul_f32 v77, v63, v75
    v_fma_f32 v53, -v72, v74, v53
    v_fma_f32 v63, -v77, v79, v63
    v_fma_f32 v53, v53, v70, v72
    v_fma_f32 v63, v63, v75, v77
    v_sub_f32 v54, v34, v73
    v_sub_f32 v64, v44, v78
    v_sub_f32 v55, v35, v73
    v_sub_f32 v65, v45, v78
    v_cvt_pk_bf16_f32 v72, v54, v55
    v_cvt_pk_bf16_f32 v77, v64, v65
    v_lshlrev_b32 v54, 16, v72
    v_lshlrev_b32 v64, 16, v77
    v_and_b32 v55, 0xffff0000, v72
    v_and_b32 v65, 0xffff0000, v77
    v_mul_f32 v72, v54, v70
    v_mul_f32 v77, v64, v75
    v_fma_f32 v54, -v72, v74, v54
    v_fma_f32 v64, -v77, v79, v64
    v_fma_f32 v54, v54, v70, v72
    v_fma_f32 v64, v64, v75, v77
    v_mul_f32 v72, v55, v70
    v_mul_f32 v77, v65, v75
    v_fma_f32 v55, -v72, v74, v55
    v_fma_f32 v65, -v77, v79, v65
    v_fma_f32 v55, v55, v70, v72
    v_fma_f32 v65, v65, v75, v77
    v_sub_f32 v56, v36, v73
    v_sub_f32 v66, v46, v78
    v_sub_f32 v57, v37, v73
    v_sub_f32 v67, v47, v78
    v_cvt_pk_bf16_f32 v72, v56, v57
    v_cvt_pk_bf16_f32 v77, v66, v67
    v_lshlrev_b32 v56, 16, v72
    v_lshlrev_b32 v66, 16, v77
    v_and_b32 v57, 0xffff0000, v72
    v_and_b32 v67, 0xffff0000, v77
    v_mul_f32 v72, v56, v70
    v_mul_f32 v77, v66, v75
    v_fma_f32 v56, -v72, v74, v56
    v_fma_f32 v66, -v77, v79, v66
    v_fma_f32 v56, v56, v70, v72
    v_fma_f32 v66, v66, v75, v77
    v_mul_f32 v72, v57, v70
    v_mul_f32 v77, v67, v75
    v_fma_f32 v57, -v72, v74, v57
    v_fma_f32 v67, -v77, v79, v67
    v_fma_f32 v57, v57, v70, v72
    v_fma_f32 v67, v67, v75, v77
    v_sub_f32 v58, v38, v73
    v_sub_f32 v68, v48, v78
    v_sub_f32 v59, v39, v73
    v_sub_f32 v69, v49, v78
    v_cvt_pk_bf16_f32 v72, v58, v59
    v_cvt_pk_bf16_f32 v77, v68, v69
    v_lshlrev_b32 v58, 16, v72
    v_lshlrev_b32 v68, 16, v77
    v_and_b32 v59, 0xffff0000, v72
    v_and_b32 v69, 0xffff0000, v77
    v_mul_f32 v72, v58, v70
    v_mul_f32 v77, v68, v75
    v_fma_f32 v58, -v72, v74, v58
    v_fma_f32 v68, -v77, v79, v68
    v_fma_f32 v58, v58, v70, v72
    v_fma_f32 v68, v68, v75, v77
    v_mul_f32 v72, v59, v70
    v_mul_f32 v77, v69, v75
    v_fma_f32 v59, -v72, v74, v59
    v_fma_f32 v69, -v77, v79, v69
    v_fma_f32 v59, v59, v70, v72
    v_fma_f32 v69, v69, v75, v77
    v_cvt_pk_bf16_f32 v72, v50, v51
    v_cvt_pk_bf16_f32 v77, v60, v61
    v_lshlrev_b32 v50, 16, v72
    v_lshlrev_b32 v60, 16, v77
    v_and_b32 v51, 0xffff0000, v72
    v_and_b32 v61, 0xffff0000, v77
    v_cvt_pk_bf16_f32 v72, v52, v53
    v_cvt_pk_bf16_f32 v77, v62, v63
    v_lshlrev_b32 v52, 16, v72
    v_lshlrev_b32 v62, 16, v77
    v_and_b32 v53, 0xffff0000, v72
    v_and_b32 v63, 0xffff0000, v77
    v_cvt_pk_bf16_f32 v72, v54, v55
    v_cvt_pk_bf16_f32 v77, v64, v65
    v_lshlrev_b32 v54, 16, v72
    v_lshlrev_b32 v64, 16, v77
    v_and_b32 v55, 0xffff0000, v72
    v_and_b32 v65, 0xffff0000, v77
    v_cvt_pk_bf16_f32 v72, v56, v57
    v_cvt_pk_bf16_f32 v77, v66, v67
    v_lshlrev_b32 v56, 16, v72
    v_lshlrev_b32 v66, 16, v77
    v_and_b32 v57, 0xffff0000, v72
    v_and_b32 v67, 0xffff0000, v77
    v_cvt_pk_bf16_f32 v72, v58, v59
    v_cvt_pk_bf16_f32 v77, v68, v69
    v_lshlrev_b32 v58, 16, v72
    v_lshlrev_b32 v68, 16, v77
    v_and_b32 v59, 0xffff0000, v72
    v_and_b32 v69, 0xffff0000, v77
    v_add_f32 v70, v50, v51
    v_add_f32 v75, v60, v61
    v_add_f32 v70, v70, v52
    v_add_f32 v75, v75, v62
    v_add_f32 v70, v70, v53
    v_add_f32 v75, v75, v63
    v_add_f32 v70, v70, v54
    v_add_f32 v75, v75, v64
    v_add_f32 v70, v70, v55
    v_add_f32 v75, v75, v65
    v_add_f32 v70, v70, v56
    v_add_f32 v75, v75, v66
    v_add_f32 v70, v70, v57
    v_add_f32 v75, v75, v67
    v_add_f32 v70, v70, v58
    v_add_f32 v75, v75, v68
    v_add_f32 v70, v70, v59
    v_add_f32 v75, v75, v69
    s_nop 0
    v_add_f32_dpp v70, v70, v70 quad_perm:[1,0,3,2] row_mask:0xf bank_mask:0xf
    v_add_f32_dpp v75, v75, v75 quad_perm:[1,0,3,2] row_mask:0xf bank_mask:0xf
    s_nop 0
    v_add_f32_dpp v70, v70, v70 quad_perm:[2,3,0,1] row_mask:0xf bank_mask:0xf
    v_add_f32_dpp v75, v75, v75 quad_perm:[2,3,0,1] row_mask:0xf bank_mask:0xf
    s_nop 0
    v_add_f32_dpp v70, v70, v70 row_half_mirror row_mask:0xf bank_mask:0xf
    v_add_f32_dpp v75, v75, v75 row_half_mirror row_mask:0xf bank_mask:0xf
    s_nop 0
    v_add_f32_dpp v70, v70, v70 row_mirror row_mask:0xf bank_mask:0xf
    v_add_f32_dpp v75, v75, v75 row_mirror row_mask:0xf bank_mask:0xf
    s_nop 0
    v_add_f32_dpp v70, v70, v70 row_bcast:15 row_mask:0xa bank_mask:0xf
    v_add_f32_dpp v75, v75, v75 row_bcast:15 row_mask:0xa bank_mask:0xf
    s_nop 0
    v_add_f32_dpp v70, v70, v70 row_bcast:31 row_mask:0xc bank_mask:0xf
    v_add_f32_dpp v75, v75, v75 row_bcast:31 row_mask:0xc bank_mask:0xf
    s_nop 0
    v_readlane_b32 s28, v70, 63
    v_readlane_b32 s29, v75, 63
    s_nop 1
    v_mov_b32 v71, s28
    v_mov_b32 v76, s29
    v_mul_f32 v71, 0x3acccccd, v71
    v_mul_f32 v76, 0x3acccccd, v76
    v_sub_f32 v72, v50, v71
    v_sub_f32 v77, v60, v76
    v_mul_f32 v70, v72, v72
    v_mul_f32 v75, v77, v77
    v_sub_f32 v72, v51, v71
    v_sub_f32 v77, v61, v76
    v_fmac_f32 v70, v72, v72
    v_fmac_f32 v75, v77, v77
    v_sub_f32 v72, v52, v71
    v_sub_f32 v77, v62, v76
    v_fmac_f32 v70, v72, v72
    v_fmac_f32 v75, v77, v77
    v_sub_f32 v72, v53, v71
    v_sub_f32 v77, v63, v76
    v_fmac_f32 v70, v72, v72
    v_fmac_f32 v75, v77, v77
    v_sub_f32 v72, v54, v71
    v_sub_f32 v77, v64, v76
    v_fmac_f32 v70, v72, v72
    v_fmac_f32 v75, v77, v77
    v_sub_f32 v72, v55, v71
    v_sub_f32 v77, v65, v76
    v_fmac_f32 v70, v72, v72
    v_fmac_f32 v75, v77, v77
    v_sub_f32 v72, v56, v71
    v_sub_f32 v77, v66, v76
    v_fmac_f32 v70, v72, v72
    v_fmac_f32 v75, v77, v77
    v_sub_f32 v72, v57, v71
    v_sub_f32 v77, v67, v76
    v_fmac_f32 v70, v72, v72
    v_fmac_f32 v75, v77, v77
    v_sub_f32 v72, v58, v71
    v_sub_f32 v77, v68, v76
    v_fmac_f32 v70, v72, v72
    v_fmac_f32 v75, v77, v77
    v_sub_f32 v72, v59, v71
    v_sub_f32 v77, v69, v76
    v_fmac_f32 v70, v72, v72
    v_fmac_f32 v75, v77, v77
    s_nop 0
    v_add_f32_dpp v70, v70, v70 quad_perm:[1,0,3,2] row_mask:0xf bank_mask:0xf
    v_add_f32_dpp v75, v75, v75 quad_perm:[1,0,3,2] row_mask:0xf bank_mask:0xf
    s_nop 0
    v_add_f32_dpp v70, v70, v70 quad_perm:[2,3,0,1] row_mask:0xf bank_mask:0xf
    v_add_f32_dpp v75, v75, v75 quad_perm:[2,3,0,1] row_mask:0xf bank_mask:0xf
    s_nop 0
    v_add_f32_dpp v70, v70, v70 row_half_mirror row_mask:0xf bank_mask:0xf
    v_add_f32_dpp v75, v75, v75 row_half_mirror row_mask:0xf bank_mask:0xf
    s_nop 0
    v_add_f32_dpp v70, v70, v70 row_mirror row_mask:0xf bank_mask:0xf
    v_add_f32_dpp v75, v75, v75 row_mirror row_mask:0xf bank_mask:0xf
    s_nop 0
    v_add_f32_dpp v70, v70, v70 row_bcast:15 row_mask:0xa bank_mask:0xf
    v_add_f32_dpp v75, v75, v75 row_bcast:15 row_mask:0xa bank_mask:0xf
    s_nop 0
    v_add_f32_dpp v70, v70, v70 row_bcast:31 row_mask:0xc bank_mask:0xf
    v_add_f32_dpp v75, v75, v75 row_bcast:31 row_mask:0xc bank_mask:0xf
    s_nop 0
    v_readlane_b32 s28, v70, 63
    v_readlane_b32 s29, v75, 63
    s_nop 1
    v_mov_b32 v72, s28
    v_mov_b32 v77, s29
    v_mul_f32 v72, 0x3acccccd, v72
    v_mul_f32 v77, 0x3acccccd, v77
    v_cvt_pk_bf16_f32 v73, v71, v71
    v_cvt_pk_bf16_f32 v78, v76, v76
    v_lshlrev_b32 v73, 16, v73
    v_lshlrev_b32 v78, 16, v78
    v_cvt_pk_bf16_f32 v74, v72, v72
    v_cvt_pk_bf16_f32 v79, v77, v77
    v_lshlrev_b32 v74, 16, v74
    v_lshlrev_b32 v79, 16, v79
    v_add_f32 v74, 0x3727c5ac, v74
    v_add_f32 v79, 0x3727c5ac, v79
    v_cvt_pk_bf16_f32 v74, v74, v74
    v_cvt_pk_bf16_f32 v79, v79, v79
    v_lshlrev_b32 v74, 16, v74
    v_lshlrev_b32 v79, 16, v79
    v_sqrt_f32 v74, v74
    v_sqrt_f32 v79, v79
    s_nop 0
    v_cvt_pk_bf16_f32 v74, v74, v74
    v_cvt_pk_bf16_f32 v79, v79, v79
    v_lshlrev_b32 v74, 16, v74
    v_lshlrev_b32 v79, 16, v79
    v_rcp_f32 v70, v74
    v_rcp_f32 v75, v79
    s_nop 0
    v_sub_f32 v80, v50, v73
    v_sub_f32 v90, v60, v78
    v_sub_f32 v81, v51, v73
    v_sub_f32 v91, v61, v78
    v_cvt_pk_bf16_f32 v72, v80, v81
    v_cvt_pk_bf16_f32 v77, v90, v91
    v_lshlrev_b32 v80, 16, v72
    v_lshlrev_b32 v90, 16, v77
    v_and_b32 v81, 0xffff0000, v72
    v_and_b32 v91, 0xffff0000, v77
    v_mul_f32 v72, v80, v70
    v_mul_f32 v77, v90, v75
    v_fma_f32 v80, -v72, v74, v80
    v_fma_f32 v90, -v77, v79, v90
    v_fma_f32 v80, v80, v70, v72
    v_fma_f32 v90, v90, v75, v77
    v_mul_f32 v72, v81, v70
    v_mul_f32 v77, v91, v75
    v_fma_f32 v81, -v72, v74, v81
    v_fma_f32 v91, -v77, v79, v91
    v_fma_f32 v81, v81, v70, v72
    v_fma_f32 v91, v91, v75, v77
    v_sub_f32 v82, v52, v73
    v_sub_f32 v92, v62, v78
    v_sub_f32 v83, v53, v73
    v_sub_f32 v93, v63, v78
    v_cvt_pk_bf16_f32 v72, v82, v83
    v_cvt_pk_bf16_f32 v77, v92, v93
    v_lshlrev_b32 v82, 16, v72
    v_lshlrev_b32 v92, 16, v77
    v_and_b32 v83, 0xffff0000, v72
    v_and_b32 v93, 0xffff0000, v77
    v_mul_f32 v72, v82, v70
    v_mul_f32 v77, v92, v75
    v_fma_f32 v82, -v72, v74, v82
    v_fma_f32 v92, -v77, v79, v92
    v_fma_f32 v82, v82, v70, v72
    v_fma_f32 v92, v92, v75, v77
    v_mul_f32 v72, v83, v70
    v_mul_f32 v77, v93, v75
    v_fma_f32 v83, -v72, v74, v83
    v_fma_f32 v93, -v77, v79, v93
    v_fma_f32 v83, v83, v70, v72
    v_fma_f32 v93, v93, v75, v77
    v_sub_f32 v84, v54, v73
    v_sub_f32 v94, v64, v78
    v_sub_f32 v85, v55, v73
    v_sub_f32 v95, v65, v78
    v_cvt_pk_bf16_f32 v72, v84, v85
    v_cvt_pk_bf16_f32 v77, v94, v95
    v_lshlrev_b32 v84, 16, v72
    v_lshlrev_b32 v94, 16, v77
    v_and_b32 v85, 0xffff0000, v72
    v_and_b32 v95, 0xffff0000, v77
    v_mul_f32 v72, v84, v70
    v_mul_f32 v77, v94, v75
    v_fma_f32 v84, -v72, v74, v84
    v_fma_f32 v94, -v77, v79, v94
    v_fma_f32 v84, v84, v70, v72
    v_fma_f32 v94, v94, v75, v77
    v_mul_f32 v72, v85, v70
    v_mul_f32 v77, v95, v75
    v_fma_f32 v85, -v72, v74, v85
    v_fma_f32 v95, -v77, v79, v95
    v_fma_f32 v85, v85, v70, v72
    v_fma_f32 v95, v95, v75, v77
    v_sub_f32 v86, v56, v73
    v_sub_f32 v96, v66, v78
    v_sub_f32 v87, v57, v73
    v_sub_f32 v97, v67, v78
    v_cvt_pk_bf16_f32 v72, v86, v87
    v_cvt_pk_bf16_f32 v77, v96, v97
    v_lshlrev_b32 v86, 16, v72
    v_lshlrev_b32 v96, 16, v77
    v_and_b32 v87, 0xffff0000, v72
    v_and_b32 v97, 0xffff0000, v77
    v_mul_f32 v72, v86, v70
    v_mul_f32 v77, v96, v75
    v_fma_f32 v86, -v72, v74, v86
    v_fma_f32 v96, -v77, v79, v96
    v_fma_f32 v86, v86, v70, v72
    v_fma_f32 v96, v96, v75, v77
    v_mul_f32 v72, v87, v70
    v_mul_f32 v77, v97, v75
    v_fma_f32 v87, -v72, v74, v87
    v_fma_f32 v97, -v77, v79, v97
    v_fma_f32 v87, v87, v70, v72
    v_fma_f32 v97, v97, v75, v77
    v_sub_f32 v88, v58, v73
    v_sub_f32 v98, v68, v78
    v_sub_f32 v89, v59, v73
    v_sub_f32 v99, v69, v78
    v_cvt_pk_bf16_f32 v72, v88, v89
    v_cvt_pk_bf16_f32 v77, v98, v99
    v_lshlrev_b32 v88, 16, v72
    v_lshlrev_b32 v98, 16, v77
    v_and_b32 v89, 0xffff0000, v72
    v_and_b32 v99, 0xffff0000, v77
    v_mul_f32 v72, v88, v70
    v_mul_f32 v77, v98, v75
    v_fma_f32 v88, -v72, v74, v88
    v_fma_f32 v98, -v77, v79, v98
    v_fma_f32 v88, v88, v70, v72
    v_fma_f32 v98, v98, v75, v77
    v_mul_f32 v72, v89, v70
    v_mul_f32 v77, v99, v75
    v_fma_f32 v89, -v72, v74, v89
    v_fma_f32 v99, -v77, v79, v99
    v_fma_f32 v89, v89, v70, v72
    v_fma_f32 v99, v99, v75, v77
    v_cvt_pk_bf16_f32 v110, v80, v81
    buffer_store_dword v110, v3, s[24:27], s16 offen offset:0
    v_cvt_pk_bf16_f32 v110, v82, v83
    buffer_store_dword v110, v3, s[24:27], s16 offen offset:256
    v_cvt_pk_bf16_f32 v110, v84, v85
    buffer_store_dword v110, v3, s[24:27], s16 offen offset:512
    v_cvt_pk_bf16_f32 v110, v86, v87
    buffer_store_dword v110, v3, s[24:27], s16 offen offset:768
    v_cvt_pk_bf16_f32 v110, v88, v89
    buffer_store_dword v110, v3, s[24:27], s16 offen offset:1024
    v_cvt_pk_bf16_f32 v110, v90, v91
    buffer_store_dword v110, v3, s[24:27], s16 offen offset:1280
    v_cvt_pk_bf16_f32 v110, v92, v93
    buffer_store_dword v110, v3, s[24:27], s16 offen offset:1536
    v_cvt_pk_bf16_f32 v110, v94, v95
    buffer_store_dword v110, v3, s[24:27], s16 offen offset:1792
    v_cvt_pk_bf16_f32 v110, v96, v97
    buffer_store_dword v110, v3, s[24:27], s16 offen offset:2048
    v_cvt_pk_bf16_f32 v110, v98, v99
    buffer_store_dword v110, v3, s[24:27], s16 offen offset:2304
L_k3_end:
    s_endpgm
.globl k4_gemm1_kernel
.p2align 8
.type k4_gemm1_kernel,@function
k4_gemm1_kernel:
    s_cmp_ge_u32 s2, 240
    s_cbranch_scc1 L_k4_end
    s_load_dwordx2 s[4:5], s[0:1], 112
    s_load_dwordx2 s[6:7], s[0:1], 64
    s_load_dwordx2 s[24:25], s[0:1], 72
    s_and_b32 s26, s2, 7
    s_lshr_b32 s27, s2, 3
    s_mul_i32 s28, s27, 171
    s_lshr_b32 s28, s28, 9
    s_mul_i32 s29, s28, 3
    s_sub_u32 s29, s27, s29
    s_mul_i32 s30, s26, 3
    s_add_u32 s29, s29, s30
    s_lshl_b32 s32, s28, 7
    s_lshl_b32 s33, s29, 7
    s_waitcnt lgkmcnt(0)
    s_add_u32 s8, s4, 7864320
    s_addc_u32 s9, s5, 0
    s_mov_b32 s10, 2621440
    s_mov_b32 s11, 0x00020000
    s_mov_b32 s12, s6
    s_mov_b32 s13, s7
    s_mov_b32 s14, 6291456
    s_mov_b32 s15, 0x00020000
    s_add_u32 s16, s4, 10485760
    s_addc_u32 s17, s5, 0
    s_mov_b32 s18, 1966080
    s_mov_b32 s19, 0x00020000
    s_mov_b32 s20, s24
    s_mov_b32 s21, s25
    s_mov_b32 s22, 3072
    s_mov_b32 s23, 0x00020000
    s_mov_b32 s34, s32
    s_mov_b32 s35, s33
    v_lshrrev_b32 v3, 3, v0
    v_and_b32 v4, 7, v0
    v_lshlrev_b32 v5, 4, v4
    v_mul_u32_u24 v6, 1280, v3
    v_add_u32 v6, v6, v5
    v_add_u32 v7, 40960, v6
    v_mul_u32_u24 v8, 3072, v3
    v_add_u32 v8, v8, v5
    v_add_u32 v9, 98304, v8
    v_mul_u32_u24 v10, 320, v3
    v_add_u32 v10, v10, v5
    v_and_b32 v1, 63, v0
    v_lshrrev_b32 v2, 6, v0
    v_lshrrev_b32 v3, 5, v1
    v_lshlrev_b32 v3, 3, v3
    v_and_b32 v4, 15, v1
    v_lshrrev_b32 v4, 2, v4
    v_add_u32 v3, v3, v4
    v_mul_u32_u24 v3, 320, v3
    v_lshrrev_b32 v4, 4, v1
    v_and_b32 v4, 1, v4
    v_lshlrev_b32 v4, 5, v4
    v_and_b32 v5, 3, v1
    v_lshlrev_b32 v5, 3, v5
    v_add_u32 v4, v4, v5
    v_add_u32 v3, v3, v4
    v_and_b32 v4, 1, v2
    v_lshlrev_b32 v4, 6, v4
    v_add_u32 v11, v3, v4
    v_lshrrev_b32 v4, 1, v2
    v_lshlrev_b32 v4, 6, v4
    v_add_u32 v12, v3, v4
    v_add_u32 v12, 128, v12
    v_mov_b32 v16, 0
    v_mov_b32 v17, 0
    v_mov_b32 v18, 0
    v_mov_b32 v19, 0
    v_mov_b32 v20, 0
    v_mov_b32 v21, 0
    v_mov_b32 v22, 0
    v_mov_b32 v23, 0
    v_mov_b32 v24, 0
    v_mov_b32 v25, 0
    v_mov_b32 v26, 0
    v_mov_b32 v27, 0
    v_mov_b32 v28, 0
    v_mov_b32 v29, 0
    v_mov_b32 v30, 0
    v_mov_b32 v31, 0
    buffer_load_dwordx4 v[64:67], v6, s[8:11], s34 offen
    buffer_load_dwordx4 v[68:71], v7, s[8:11], s34 offen
    buffer_load_dwordx4 v[72:75], v8, s[12:15], s35 offen
    buffer_load_dwordx4 v[76:79], v9, s[12:15], s35 offen
    s_add_u32 s34, s34, 81920
    s_add_u32 s35, s35, 196608
    buffer_load_dwordx4 v[80:83], v6, s[8:11], s34 offen
    buffer_load_dwordx4 v[84:87], v7, s[8:11], s34 offen
    buffer_load_dwordx4 v[88:91], v8, s[12:15], s35 offen
    buffer_load_dwordx4 v[92:95], v9, s[12:15], s35 offen
    s_add_u32 s34, s34, 81920
    s_add_u32 s35, s35, 196608
    buffer_load_dwordx4 v[96:99], v6, s[8:11], s34 offen
    buffer_load_dwordx4 v[100:103], v7, s[8:11], s34 offen
    buffer_load_dwordx4 v[104:107], v8, s[12:15], s35 offen
    buffer_load_dwordx4 v[108:111], v9, s[12:15], s35 offen
    s_add_u32 s34, s34, 81920
    s_add_u32 s35, s35, 196608
    buffer_load_dwordx4 v[112:115], v6, s[8:11], s34 offen
    buffer_load_dwordx4 v[116:119], v7, s[8:11], s34 offen
    buffer_load_dwordx4 v[120:123], v8, s[12:15], s35 offen
    buffer_load_dwordx4 v[124:127], v9, s[12:15], s35 offen
    s_add_u32 s34, s34, 81920
    s_add_u32 s35, s35, 196608
    buffer_load_dwordx4 v[128:131], v6, s[8:11], s34 offen
    buffer_load_dwordx4 v[132:135], v7, s[8:11], s34 offen
    buffer_load_dwordx4 v[136:139], v8, s[12:15], s35 offen
    buffer_load_dwordx4 v[140:143], v9, s[12:15], s35 offen
    s_add_u32 s34, s34, 81920
    s_add_u32 s35, s35, 196608
    buffer_load_dwordx4 v[144:147], v6, s[8:11], s34 offen
    buffer_load_dwordx4 v[148:151], v7, s[8:11], s34 offen
    buffer_load_dwordx4 v[152:155], v8, s[12:15], s35 offen
    buffer_load_dwordx4 v[156:159], v9, s[12:15], s35 offen
    s_add_u32 s34, s34, 81920
    s_add_u32 s35, s35, 196608
    buffer_load_dwordx4 v[160:163], v6, s[8:11], s34 offen
    buffer_load_dwordx4 v[164:167], v7, s[8:11], s34 offen
    buffer_load_dwordx4 v[168:171], v8, s[12:15], s35 offen
    buffer_load_dwordx4 v[172:175], v9, s[12:15], s35 offen
    s_add_u32 s34, s34, 81920
    s_add_u32 s35, s35, 196608
    buffer_load_dwordx4 v[176:179], v6, s[8:11], s34 offen
    buffer_load_dwordx4 v[180:183], v7, s[8:11], s34 offen
    buffer_load_dwordx4 v[184:187], v8, s[12:15], s35 offen
    buffer_load_dwordx4 v[188:191], v9, s[12:15], s35 offen
    s_add_u32 s34, s34, 81920
    s_add_u32 s35, s35, 196608
    s_waitcnt vmcnt(28)
    ds_write_b128 v10, v[64:67] offset:0
    ds_write_b128 v10, v[68:71] offset:10240
    ds_write_b128 v10, v[72:75] offset:128
    ds_write_b128 v10, v[76:79] offset:10368
    s_waitcnt lgkmcnt(0)
    buffer_load_dwordx4 v[64:67], v6, s[8:11], s34 offen
    buffer_load_dwordx4 v[68:71], v7, s[8:11], s34 offen
    buffer_load_dwordx4 v[72:75], v8, s[12:15], s35 offen
    buffer_load_dwordx4 v[76:79], v9, s[12:15], s35 offen
    s_add_u32 s34, s34, 81920
    s_add_u32 s35, s35, 196608
    s_barrier
    ds_read_b64_tr_b16 v[32:33], v11 offset:0
    ds_read_b64_tr_b16 v[34:35], v11 offset:1280
    ds_read_b64_tr_b16 v[48:49], v12 offset:0
    ds_read_b64_tr_b16 v[50:51], v12 offset:1280
    ds_read_b64_tr_b16 v[36:37], v11 offset:5120
    ds_read_b64_tr_b16 v[38:39], v11 offset:6400
    ds_read_b64_tr_b16 v[52:53], v12 offset:5120
    ds_read_b64_tr_b16 v[54:55], v12 offset:6400
    ds_read_b64_tr_b16 v[40:41], v11 offset:10240
    ds_read_b64_tr_b16 v[42:43], v11 offset:11520
    ds_read_b64_tr_b16 v[56:57], v12 offset:10240
    ds_read_b64_tr_b16 v[58:59], v12 offset:11520
    ds_read_b64_tr_b16 v[44:45], v11 offset:15360
    ds_read_b64_tr_b16 v[46:47], v11 offset:16640
    ds_read_b64_tr_b16 v[60:61], v12 offset:15360
    ds_read_b64_tr_b16 v[62:63], v12 offset:16640
    s_waitcnt lgkmcnt(12)
    v_mfma_f32_32x32x16_bf16 v[16:31], v[32:35], v[48:51], v[16:31]
    s_waitcnt lgkmcnt(8)
    v_mfma_f32_32x32x16_bf16 v[16:31], v[36:39], v[52:55], v[16:31]
    s_waitcnt lgkmcnt(4)
    v_mfma_f32_32x32x16_bf16 v[16:31], v[40:43], v[56:59], v[16:31]
    s_waitcnt lgkmcnt(0)
    v_mfma_f32_32x32x16_bf16 v[16:31], v[44:47], v[60:63], v[16:31]
    s_waitcnt vmcnt(28)
    ds_write_b128 v10, v[80:83] offset:20480
    ds_write_b128 v10, v[84:87] offset:30720
    ds_write_b128 v10, v[88:91] offset:20608
    ds_write_b128 v10, v[92:95] offset:30848
    s_waitcnt lgkmcnt(0)
    buffer_load_dwordx4 v[80:83], v6, s[8:11], s34 offen
    buffer_load_dwordx4 v[84:87], v7, s[8:11], s34 offen
    buffer_load_dwordx4 v[88:91], v8, s[12:15], s35 offen
    buffer_load_dwordx4 v[92:95], v9, s[12:15], s35 offen
    s_add_u32 s34, s34, 81920
    s_add_u32 s35, s35, 196608
    s_barrier
    ds_read_b64_tr_b16 v[32:33], v11 offset:20480
    ds_read_b64_tr_b16 v[34:35], v11 offset:21760
    ds_read_b64_tr_b16 v[48:49], v12 offset:20480
    ds_read_b64_tr_b16 v[50:51], v12 offset:21760
    ds_read_b64_tr_b16 v[36:37], v11 offset:25600
    ds_read_b64_tr_b16 v[38:39], v11 offset:26880
    ds_read_b64_tr_b16 v[52:53], v12 offset:25600
    ds_read_b64_tr_b16 v[54:55], v12 offset:26880
    ds_read_b64_tr_b16 v[40:41], v11 offset:30720
    ds_read_b64_tr_b16 v[42:43], v11 offset:32000
    ds_read_b64_tr_b16 v[56:57], v12 offset:30720
    ds_read_b64_tr_b16 v[58:59], v12 offset:32000
    ds_read_b64_tr_b16 v[44:45], v11 offset:35840
    ds_read_b64_tr_b16 v[46:47], v11 offset:37120
    ds_read_b64_tr_b16 v[60:61], v12 offset:35840
    ds_read_b64_tr_b16 v[62:63], v12 offset:37120
    s_waitcnt lgkmcnt(12)
    v_mfma_f32_32x32x16_bf16 v[16:31], v[32:35], v[48:51], v[16:31]
    s_waitcnt lgkmcnt(8)
    v_mfma_f32_32x32x16_bf16 v[16:31], v[36:39], v[52:55], v[16:31]
    s_waitcnt lgkmcnt(4)
    v_mfma_f32_32x32x16_bf16 v[16:31], v[40:43], v[56:59], v[16:31]
    s_waitcnt lgkmcnt(0)
    v_mfma_f32_32x32x16_bf16 v[16:31], v[44:47], v[60:63], v[16:31]
    s_waitcnt vmcnt(28)
    ds_write_b128 v10, v[96:99] offset:0
    ds_write_b128 v10, v[100:103] offset:10240
    ds_write_b128 v10, v[104:107] offset:128
    ds_write_b128 v10, v[108:111] offset:10368
    s_waitcnt lgkmcnt(0)
    buffer_load_dwordx4 v[96:99], v6, s[8:11], s34 offen
    buffer_load_dwordx4 v[100:103], v7, s[8:11], s34 offen
    buffer_load_dwordx4 v[104:107], v8, s[12:15], s35 offen
    buffer_load_dwordx4 v[108:111], v9, s[12:15], s35 offen
    s_add_u32 s34, s34, 81920
    s_add_u32 s35, s35, 196608
    s_barrier
    ds_read_b64_tr_b16 v[32:33], v11 offset:0
    ds_read_b64_tr_b16 v[34:35], v11 offset:1280
    ds_read_b64_tr_b16 v[48:49], v12 offset:0
    ds_read_b64_tr_b16 v[50:51], v12 offset:1280
    ds_read_b64_tr_b16 v[36:37], v11 offset:5120
    ds_read_b64_tr_b16 v[38:39], v11 offset:6400
    ds_read_b64_tr_b16 v[52:53], v12 offset:5120
    ds_read_b64_tr_b16 v[54:55], v12 offset:6400
    ds_read_b64_tr_b16 v[40:41], v11 offset:10240
    ds_read_b64_tr_b16 v[42:43], v11 offset:11520
    ds_read_b64_tr_b16 v[56:57], v12 offset:10240
    ds_read_b64_tr_b16 v[58:59], v12 offset:11520
    ds_read_b64_tr_b16 v[44:45], v11 offset:15360
    ds_read_b64_tr_b16 v[46:47], v11 offset:16640
    ds_read_b64_tr_b16 v[60:61], v12 offset:15360
    ds_read_b64_tr_b16 v[62:63], v12 offset:16640
    s_waitcnt lgkmcnt(12)
    v_mfma_f32_32x32x16_bf16 v[16:31], v[32:35], v[48:51], v[16:31]
    s_waitcnt lgkmcnt(8)
    v_mfma_f32_32x32x16_bf16 v[16:31], v[36:39], v[52:55], v[16:31]
    s_waitcnt lgkmcnt(4)
    v_mfma_f32_32x32x16_bf16 v[16:31], v[40:43], v[56:59], v[16:31]
    s_waitcnt lgkmcnt(0)
    v_mfma_f32_32x32x16_bf16 v[16:31], v[44:47], v[60:63], v[16:31]
    s_waitcnt vmcnt(28)
    ds_write_b128 v10, v[112:115] offset:20480
    ds_write_b128 v10, v[116:119] offset:30720
    ds_write_b128 v10, v[120:123] offset:20608
    ds_write_b128 v10, v[124:127] offset:30848
    s_waitcnt lgkmcnt(0)
    buffer_load_dwordx4 v[112:115], v6, s[8:11], s34 offen
    buffer_load_dwordx4 v[116:119], v7, s[8:11], s34 offen
    buffer_load_dwordx4 v[120:123], v8, s[12:15], s35 offen
    buffer_load_dwordx4 v[124:127], v9, s[12:15], s35 offen
    s_add_u32 s34, s34, 81920
    s_add_u32 s35, s35, 196608
    s_barrier
    ds_read_b64_tr_b16 v[32:33], v11 offset:20480
    ds_read_b64_tr_b16 v[34:35], v11 offset:21760
    ds_read_b64_tr_b16 v[48:49], v12 offset:20480
    ds_read_b64_tr_b16 v[50:51], v12 offset:21760
    ds_read_b64_tr_b16 v[36:37], v11 offset:25600
    ds_read_b64_tr_b16 v[38:39], v11 offset:26880
    ds_read_b64_tr_b16 v[52:53], v12 offset:25600
    ds_read_b64_tr_b16 v[54:55], v12 offset:26880
    ds_read_b64_tr_b16 v[40:41], v11 offset:30720
    ds_read_b64_tr_b16 v[42:43], v11 offset:32000
    ds_read_b64_tr_b16 v[56:57], v12 offset:30720
    ds_read_b64_tr_b16 v[58:59], v12 offset:32000
    ds_read_b64_tr_b16 v[44:45], v11 offset:35840
    ds_read_b64_tr_b16 v[46:47], v11 offset:37120
    ds_read_b64_tr_b16 v[60:61], v12 offset:35840
    ds_read_b64_tr_b16 v[62:63], v12 offset:37120
    s_waitcnt lgkmcnt(12)
    v_mfma_f32_32x32x16_bf16 v[16:31], v[32:35], v[48:51], v[16:31]
    s_waitcnt lgkmcnt(8)
    v_mfma_f32_32x32x16_bf16 v[16:31], v[36:39], v[52:55], v[16:31]
    s_waitcnt lgkmcnt(4)
    v_mfma_f32_32x32x16_bf16 v[16:31], v[40:43], v[56:59], v[16:31]
    s_waitcnt lgkmcnt(0)
    v_mfma_f32_32x32x16_bf16 v[16:31], v[44:47], v[60:63], v[16:31]
    s_waitcnt vmcnt(28)
    ds_write_b128 v10, v[128:131] offset:0
    ds_write_b128 v10, v[132:135] offset:10240
    ds_write_b128 v10, v[136:139] offset:128
    ds_write_b128 v10, v[140:143] offset:10368
    s_waitcnt lgkmcnt(0)
    buffer_load_dwordx4 v[128:131], v6, s[8:11], s34 offen
    buffer_load_dwordx4 v[132:135], v7, s[8:11], s34 offen
    buffer_load_dwordx4 v[136:139], v8, s[12:15], s35 offen
    buffer_load_dwordx4 v[140:143], v9, s[12:15], s35 offen
    s_add_u32 s34, s34, 81920
    s_add_u32 s35, s35, 196608
    s_barrier
    ds_read_b64_tr_b16 v[32:33], v11 offset:0
    ds_read_b64_tr_b16 v[34:35], v11 offset:1280
    ds_read_b64_tr_b16 v[48:49], v12 offset:0
    ds_read_b64_tr_b16 v[50:51], v12 offset:1280
    ds_read_b64_tr_b16 v[36:37], v11 offset:5120
    ds_read_b64_tr_b16 v[38:39], v11 offset:6400
    ds_read_b64_tr_b16 v[52:53], v12 offset:5120
    ds_read_b64_tr_b16 v[54:55], v12 offset:6400
    ds_read_b64_tr_b16 v[40:41], v11 offset:10240
    ds_read_b64_tr_b16 v[42:43], v11 offset:11520
    ds_read_b64_tr_b16 v[56:57], v12 offset:10240
    ds_read_b64_tr_b16 v[58:59], v12 offset:11520
    ds_read_b64_tr_b16 v[44:45], v11 offset:15360
    ds_read_b64_tr_b16 v[46:47], v11 offset:16640
    ds_read_b64_tr_b16 v[60:61], v12 offset:15360
    ds_read_b64_tr_b16 v[62:63], v12 offset:16640
    s_waitcnt lgkmcnt(12)
    v_mfma_f32_32x32x16_bf16 v[16:31], v[32:35], v[48:51], v[16:31]
    s_waitcnt lgkmcnt(8)
    v_mfma_f32_32x32x16_bf16 v[16:31], v[36:39], v[52:55], v[16:31]
    s_waitcnt lgkmcnt(4)
    v_mfma_f32_32x32x16_bf16 v[16:31], v[40:43], v[56:59], v[16:31]
    s_waitcnt lgkmcnt(0)
    v_mfma_f32_32x32x16_bf16 v[16:31], v[44:47], v[60:63], v[16:31]
    s_waitcnt vmcnt(28)
    ds_write_b128 v10, v[144:147] offset:20480
    ds_write_b128 v10, v[148:151] offset:30720
    ds_write_b128 v10, v[152:155] offset:20608
    ds_write_b128 v10, v[156:159] offset:30848
    s_waitcnt lgkmcnt(0)
    buffer_load_dwordx4 v[144:147], v6, s[8:11], s34 offen
    buffer_load_dwordx4 v[148:151], v7, s[8:11], s34 offen
    buffer_load_dwordx4 v[152:155], v8, s[12:15], s35 offen
    buffer_load_dwordx4 v[156:159], v9, s[12:15], s35 offen
    s_add_u32 s34, s34, 81920
    s_add_u32 s35, s35, 196608
    s_barrier
    ds_read_b64_tr_b16 v[32:33], v11 offset:20480
    ds_read_b64_tr_b16 v[34:35], v11 offset:21760
    ds_read_b64_tr_b16 v[48:49], v12 offset:20480
    ds_read_b64_tr_b16 v[50:51], v12 offset:21760
    ds_read_b64_tr_b16 v[36:37], v11 offset:25600
    ds_read_b64_tr_b16 v[38:39], v11 offset:26880
    ds_read_b64_tr_b16 v[52:53], v12 offset:25600
    ds_read_b64_tr_b16 v[54:55], v12 offset:26880
    ds_read_b64_tr_b16 v[40:41], v11 offset:30720
    ds_read_b64_tr_b16 v[42:43], v11 offset:32000
    ds_read_b64_tr_b16 v[56:57], v12 offset:30720
    ds_read_b64_tr_b16 v[58:59], v12 offset:32000
    ds_read_b64_tr_b16 v[44:45], v11 offset:35840
    ds_read_b64_tr_b16 v[46:47], v11 offset:37120
    ds_read_b64_tr_b16 v[60:61], v12 offset:35840
    ds_read_b64_tr_b16 v[62:63], v12 offset:37120
    s_waitcnt lgkmcnt(12)
    v_mfma_f32_32x32x16_bf16 v[16:31], v[32:35], v[48:51], v[16:31]
    s_waitcnt lgkmcnt(8)
    v_mfma_f32_32x32x16_bf16 v[16:31], v[36:39], v[52:55], v[16:31]
    s_waitcnt lgkmcnt(4)
    v_mfma_f32_32x32x16_bf16 v[16:31], v[40:43], v[56:59], v[16:31]
    s_waitcnt lgkmcnt(0)
    v_mfma_f32_32x32x16_bf16 v[16:31], v[44:47], v[60:63], v[16:31]
    s_waitcnt vmcnt(28)
    ds_write_b128 v10, v[160:163] offset:0
    ds_write_b128 v10, v[164:167] offset:10240
    ds_write_b128 v10, v[168:171] offset:128
    ds_write_b128 v10, v[172:175] offset:10368
    s_waitcnt lgkmcnt(0)
    buffer_load_dwordx4 v[160:163], v6, s[8:11], s34 offen
    buffer_load_dwordx4 v[164:167], v7, s[8:11], s34 offen
    buffer_load_dwordx4 v[168:171], v8, s[12:15], s35 offen
    buffer_load_dwordx4 v[172:175], v9, s[12:15], s35 offen
    s_add_u32 s34, s34, 81920
    s_add_u32 s35, s35, 196608
    s_barrier
    ds_read_b64_tr_b16 v[32:33], v11 offset:0
    ds_read_b64_tr_b16 v[34:35], v11 offset:1280
    ds_read_b64_tr_b16 v[48:49], v12 offset:0
    ds_read_b64_tr_b16 v[50:51], v12 offset:1280
    ds_read_b64_tr_b16 v[36:37], v11 offset:5120
    ds_read_b64_tr_b16 v[38:39], v11 offset:6400
    ds_read_b64_tr_b16 v[52:53], v12 offset:5120
    ds_read_b64_tr_b16 v[54:55], v12 offset:6400
    ds_read_b64_tr_b16 v[40:41], v11 offset:10240
    ds_read_b64_tr_b16 v[42:43], v11 offset:11520
    ds_read_b64_tr_b16 v[56:57], v12 offset:10240
    ds_read_b64_tr_b16 v[58:59], v12 offset:11520
    ds_read_b64_tr_b16 v[44:45], v11 offset:15360
    ds_read_b64_tr_b16 v[46:47], v11 offset:16640
    ds_read_b64_tr_b16 v[60:61], v12 offset:15360
    ds_read_b64_tr_b16 v[62:63], v12 offset:16640
    s_waitcnt lgkmcnt(12)
    v_mfma_f32_32x32x16_bf16 v[16:31], v[32:35], v[48:51], v[16:31]
    s_waitcnt lgkmcnt(8)
    v_mfma_f32_32x32x16_bf16 v[16:31], v[36:39], v[52:55], v[16:31]
    s_waitcnt lgkmcnt(4)
    v_mfma_f32_32x32x16_bf16 v[16:31], v[40:43], v[56:59], v[16:31]
    s_waitcnt lgkmcnt(0)
    v_mfma_f32_32x32x16_bf16 v[16:31], v[44:47], v[60:63], v[16:31]
    s_waitcnt vmcnt(28)
    ds_write_b128 v10, v[176:179] offset:20480
    ds_write_b128 v10, v[180:183] offset:30720
    ds_write_b128 v10, v[184:187] offset:20608
    ds_write_b128 v10, v[188:191] offset:30848
    s_waitcnt lgkmcnt(0)
    buffer_load_dwordx4 v[176:179], v6, s[8:11], s34 offen
    buffer_load_dwordx4 v[180:183], v7, s[8:11], s34 offen
    buffer_load_dwordx4 v[184:187], v8, s[12:15], s35 offen
    buffer_load_dwordx4 v[188:191], v9, s[12:15], s35 offen
    s_add_u32 s34, s34, 81920
    s_add_u32 s35, s35, 196608
    s_barrier
    ds_read_b64_tr_b16 v[32:33], v11 offset:20480
    ds_read_b64_tr_b16 v[34:35], v11 offset:21760
    ds_read_b64_tr_b16 v[48:49], v12 offset:20480
    ds_read_b64_tr_b16 v[50:51], v12 offset:21760
    ds_read_b64_tr_b16 v[36:37], v11 offset:25600
    ds_read_b64_tr_b16 v[38:39], v11 offset:26880
    ds_read_b64_tr_b16 v[52:53], v12 offset:25600
    ds_read_b64_tr_b16 v[54:55], v12 offset:26880
    ds_read_b64_tr_b16 v[40:41], v11 offset:30720
    ds_read_b64_tr_b16 v[42:43], v11 offset:32000
    ds_read_b64_tr_b16 v[56:57], v12 offset:30720
    ds_read_b64_tr_b16 v[58:59], v12 offset:32000
    ds_read_b64_tr_b16 v[44:45], v11 offset:35840
    ds_read_b64_tr_b16 v[46:47], v11 offset:37120
    ds_read_b64_tr_b16 v[60:61], v12 offset:35840
    ds_read_b64_tr_b16 v[62:63], v12 offset:37120
    s_waitcnt lgkmcnt(12)
    v_mfma_f32_32x32x16_bf16 v[16:31], v[32:35], v[48:51], v[16:31]
    s_waitcnt lgkmcnt(8)
    v_mfma_f32_32x32x16_bf16 v[16:31], v[36:39], v[52:55], v[16:31]
    s_waitcnt lgkmcnt(4)
    v_mfma_f32_32x32x16_bf16 v[16:31], v[40:43], v[56:59], v[16:31]
    s_waitcnt lgkmcnt(0)
    v_mfma_f32_32x32x16_bf16 v[16:31], v[44:47], v[60:63], v[16:31]
    s_waitcnt vmcnt(28)
    ds_write_b128 v10, v[64:67] offset:0
    ds_write_b128 v10, v[68:71] offset:10240
    ds_write_b128 v10, v[72:75] offset:128
    ds_write_b128 v10, v[76:79] offset:10368
    s_waitcnt lgkmcnt(0)
    buffer_load_dwordx4 v[64:67], v6, s[8:11], s34 offen
    buffer_load_dwordx4 v[68:71], v7, s[8:11], s34 offen
    buffer_load_dwordx4 v[72:75], v8, s[12:15], s35 offen
    buffer_load_dwordx4 v[76:79], v9, s[12:15], s35 offen
    s_add_u32 s34, s34, 81920
    s_add_u32 s35, s35, 196608
    s_barrier
    ds_read_b64_tr_b16 v[32:33], v11 offset:0
    ds_read_b64_tr_b16 v[34:35], v11 offset:1280
    ds_read_b64_tr_b16 v[48:49], v12 offset:0
    ds_read_b64_tr_b16 v[50:51], v12 offset:1280
    ds_read_b64_tr_b16 v[36:37], v11 offset:5120
    ds_read_b64_tr_b16 v[38:39], v11 offset:6400
    ds_read_b64_tr_b16 v[52:53], v12 offset:5120
    ds_read_b64_tr_b16 v[54:55], v12 offset:6400
    ds_read_b64_tr_b16 v[40:41], v11 offset:10240
    ds_read_b64_tr_b16 v[42:43], v11 offset:11520
    ds_read_b64_tr_b16 v[56:57], v12 offset:10240
    ds_read_b64_tr_b16 v[58:59], v12 offset:11520
    ds_read_b64_tr_b16 v[44:45], v11 offset:15360
    ds_read_b64_tr_b16 v[46:47], v11 offset:16640
    ds_read_b64_tr_b16 v[60:61], v12 offset:15360
    ds_read_b64_tr_b16 v[62:63], v12 offset:16640
    s_waitcnt lgkmcnt(12)
    v_mfma_f32_32x32x16_bf16 v[16:31], v[32:35], v[48:51], v[16:31]
    s_waitcnt lgkmcnt(8)
    v_mfma_f32_32x32x16_bf16 v[16:31], v[36:39], v[52:55], v[16:31]
    s_waitcnt lgkmcnt(4)
    v_mfma_f32_32x32x16_bf16 v[16:31], v[40:43], v[56:59], v[16:31]
    s_waitcnt lgkmcnt(0)
    v_mfma_f32_32x32x16_bf16 v[16:31], v[44:47], v[60:63], v[16:31]
    s_waitcnt vmcnt(28)
    ds_write_b128 v10, v[80:83] offset:20480
    ds_write_b128 v10, v[84:87] offset:30720
    ds_write_b128 v10, v[88:91] offset:20608
    ds_write_b128 v10, v[92:95] offset:30848
    s_waitcnt lgkmcnt(0)
    buffer_load_dwordx4 v[80:83], v6, s[8:11], s34 offen
    buffer_load_dwordx4 v[84:87], v7, s[8:11], s34 offen
    buffer_load_dwordx4 v[88:91], v8, s[12:15], s35 offen
    buffer_load_dwordx4 v[92:95], v9, s[12:15], s35 offen
    s_add_u32 s34, s34, 81920
    s_add_u32 s35, s35, 196608
    s_barrier
    ds_read_b64_tr_b16 v[32:33], v11 offset:20480
    ds_read_b64_tr_b16 v[34:35], v11 offset:21760
    ds_read_b64_tr_b16 v[48:49], v12 offset:20480
    ds_read_b64_tr_b16 v[50:51], v12 offset:21760
    ds_read_b64_tr_b16 v[36:37], v11 offset:25600
    ds_read_b64_tr_b16 v[38:39], v11 offset:26880
    ds_read_b64_tr_b16 v[52:53], v12 offset:25600
    ds_read_b64_tr_b16 v[54:55], v12 offset:26880
    ds_read_b64_tr_b16 v[40:41], v11 offset:30720
    ds_read_b64_tr_b16 v[42:43], v11 offset:32000
    ds_read_b64_tr_b16 v[56:57], v12 offset:30720
    ds_read_b64_tr_b16 v[58:59], v12 offset:32000
    ds_read_b64_tr_b16 v[44:45], v11 offset:35840
    ds_read_b64_tr_b16 v[46:47], v11 offset:37120
    ds_read_b64_tr_b16 v[60:61], v12 offset:35840
    ds_read_b64_tr_b16 v[62:63], v12 offset:37120
    s_waitcnt lgkmcnt(12)
    v_mfma_f32_32x32x16_bf16 v[16:31], v[32:35], v[48:51], v[16:31]
    s_waitcnt lgkmcnt(8)
    v_mfma_f32_32x32x16_bf16 v[16:31], v[36:39], v[52:55], v[16:31]
    s_waitcnt lgkmcnt(4)
    v_mfma_f32_32x32x16_bf16 v[16:31], v[40:43], v[56:59], v[16:31]
    s_waitcnt lgkmcnt(0)
    v_mfma_f32_32x32x16_bf16 v[16:31], v[44:47], v[60:63], v[16:31]
    s_waitcnt vmcnt(28)
    ds_write_b128 v10, v[96:99] offset:0
    ds_write_b128 v10, v[100:103] offset:10240
    ds_write_b128 v10, v[104:107] offset:128
    ds_write_b128 v10, v[108:111] offset:10368
    s_waitcnt lgkmcnt(0)
    buffer_load_dwordx4 v[96:99], v6, s[8:11], s34 offen
    buffer_load_dwordx4 v[100:103], v7, s[8:11], s34 offen
    buffer_load_dwordx4 v[104:107], v8, s[12:15], s35 offen
    buffer_load_dwordx4 v[108:111], v9, s[12:15], s35 offen
    s_add_u32 s34, s34, 81920
    s_add_u32 s35, s35, 196608
    s_barrier
    ds_read_b64_tr_b16 v[32:33], v11 offset:0
    ds_read_b64_tr_b16 v[34:35], v11 offset:1280
    ds_read_b64_tr_b16 v[48:49], v12 offset:0
    ds_read_b64_tr_b16 v[50:51], v12 offset:1280
    ds_read_b64_tr_b16 v[36:37], v11 offset:5120
    ds_read_b64_tr_b16 v[38:39], v11 offset:6400
    ds_read_b64_tr_b16 v[52:53], v12 offset:5120
    ds_read_b64_tr_b16 v[54:55], v12 offset:6400
    ds_read_b64_tr_b16 v[40:41], v11 offset:10240
    ds_read_b64_tr_b16 v[42:43], v11 offset:11520
    ds_read_b64_tr_b16 v[56:57], v12 offset:10240
    ds_read_b64_tr_b16 v[58:59], v12 offset:11520
    ds_read_b64_tr_b16 v[44:45], v11 offset:15360
    ds_read_b64_tr_b16 v[46:47], v11 offset:16640
    ds_read_b64_tr_b16 v[60:61], v12 offset:15360
    ds_read_b64_tr_b16 v[62:63], v12 offset:16640
    s_waitcnt lgkmcnt(12)
    v_mfma_f32_32x32x16_bf16 v[16:31], v[32:35], v[48:51], v[16:31]
    s_waitcnt lgkmcnt(8)
    v_mfma_f32_32x32x16_bf16 v[16:31], v[36:39], v[52:55], v[16:31]
    s_waitcnt lgkmcnt(4)
    v_mfma_f32_32x32x16_bf16 v[16:31], v[40:43], v[56:59], v[16:31]
    s_waitcnt lgkmcnt(0)
    v_mfma_f32_32x32x16_bf16 v[16:31], v[44:47], v[60:63], v[16:31]
    s_waitcnt vmcnt(28)
    ds_write_b128 v10, v[112:115] offset:20480
    ds_write_b128 v10, v[116:119] offset:30720
    ds_write_b128 v10, v[120:123] offset:20608
    ds_write_b128 v10, v[124:127] offset:30848
    s_waitcnt lgkmcnt(0)
    buffer_load_dwordx4 v[112:115], v6, s[8:11], s34 offen
    buffer_load_dwordx4 v[116:119], v7, s[8:11], s34 offen
    buffer_load_dwordx4 v[120:123], v8, s[12:15], s35 offen
    buffer_load_dwordx4 v[124:127], v9, s[12:15], s35 offen
    s_add_u32 s34, s34, 81920
    s_add_u32 s35, s35, 196608
    s_barrier
    ds_read_b64_tr_b16 v[32:33], v11 offset:20480
    ds_read_b64_tr_b16 v[34:35], v11 offset:21760
    ds_read_b64_tr_b16 v[48:49], v12 offset:20480
    ds_read_b64_tr_b16 v[50:51], v12 offset:21760
    ds_read_b64_tr_b16 v[36:37], v11 offset:25600
    ds_read_b64_tr_b16 v[38:39], v11 offset:26880
    ds_read_b64_tr_b16 v[52:53], v12 offset:25600
    ds_read_b64_tr_b16 v[54:55], v12 offset:26880
    ds_read_b64_tr_b16 v[40:41], v11 offset:30720
    ds_read_b64_tr_b16 v[42:43], v11 offset:32000
    ds_read_b64_tr_b16 v[56:57], v12 offset:30720
    ds_read_b64_tr_b16 v[58:59], v12 offset:32000
    ds_read_b64_tr_b16 v[44:45], v11 offset:35840
    ds_read_b64_tr_b16 v[46:47], v11 offset:37120
    ds_read_b64_tr_b16 v[60:61], v12 offset:35840
    ds_read_b64_tr_b16 v[62:63], v12 offset:37120
    s_waitcnt lgkmcnt(12)
    v_mfma_f32_32x32x16_bf16 v[16:31], v[32:35], v[48:51], v[16:31]
    s_waitcnt lgkmcnt(8)
    v_mfma_f32_32x32x16_bf16 v[16:31], v[36:39], v[52:55], v[16:31]
    s_waitcnt lgkmcnt(4)
    v_mfma_f32_32x32x16_bf16 v[16:31], v[40:43], v[56:59], v[16:31]
    s_waitcnt lgkmcnt(0)
    v_mfma_f32_32x32x16_bf16 v[16:31], v[44:47], v[60:63], v[16:31]
    s_waitcnt vmcnt(28)
    ds_write_b128 v10, v[128:131] offset:0
    ds_write_b128 v10, v[132:135] offset:10240
    ds_write_b128 v10, v[136:139] offset:128
    ds_write_b128 v10, v[140:143] offset:10368
    s_waitcnt lgkmcnt(0)
    buffer_load_dwordx4 v[128:131], v6, s[8:11], s34 offen
    buffer_load_dwordx4 v[132:135], v7, s[8:11], s34 offen
    buffer_load_dwordx4 v[136:139], v8, s[12:15], s35 offen
    buffer_load_dwordx4 v[140:143], v9, s[12:15], s35 offen
    s_add_u32 s34, s34, 81920
    s_add_u32 s35, s35, 196608
    s_barrier
    ds_read_b64_tr_b16 v[32:33], v11 offset:0
    ds_read_b64_tr_b16 v[34:35], v11 offset:1280
    ds_read_b64_tr_b16 v[48:49], v12 offset:0
    ds_read_b64_tr_b16 v[50:51], v12 offset:1280
    ds_read_b64_tr_b16 v[36:37], v11 offset:5120
    ds_read_b64_tr_b16 v[38:39], v11 offset:6400
    ds_read_b64_tr_b16 v[52:53], v12 offset:5120
    ds_read_b64_tr_b16 v[54:55], v12 offset:6400
    ds_read_b64_tr_b16 v[40:41], v11 offset:10240
    ds_read_b64_tr_b16 v[42:43], v11 offset:11520
    ds_read_b64_tr_b16 v[56:57], v12 offset:10240
    ds_read_b64_tr_b16 v[58:59], v12 offset:11520
    ds_read_b64_tr_b16 v[44:45], v11 offset:15360
    ds_read_b64_tr_b16 v[46:47], v11 offset:16640
    ds_read_b64_tr_b16 v[60:61], v12 offset:15360
    ds_read_b64_tr_b16 v[62:63], v12 offset:16640
    s_waitcnt lgkmcnt(12)
    v_mfma_f32_32x32x16_bf16 v[16:31], v[32:35], v[48:51], v[16:31]
    s_waitcnt lgkmcnt(8)
    v_mfma_f32_32x32x16_bf16 v[16:31], v[36:39], v[52:55], v[16:31]
    s_waitcnt lgkmcnt(4)
    v_mfma_f32_32x32x16_bf16 v[16:31], v[40:43], v[56:59], v[16:31]
    s_waitcnt lgkmcnt(0)
    v_mfma_f32_32x32x16_bf16 v[16:31], v[44:47], v[60:63], v[16:31]
    s_waitcnt vmcnt(28)
    ds_write_b128 v10, v[144:147] offset:20480
    ds_write_b128 v10, v[148:151] offset:30720
    ds_write_b128 v10, v[152:155] offset:20608
    ds_write_b128 v10, v[156:159] offset:30848
    s_waitcnt lgkmcnt(0)
    buffer_load_dwordx4 v[144:147], v6, s[8:11], s34 offen
    buffer_load_dwordx4 v[148:151], v7, s[8:11], s34 offen
    buffer_load_dwordx4 v[152:155], v8, s[12:15], s35 offen
    buffer_load_dwordx4 v[156:159], v9, s[12:15], s35 offen
    s_add_u32 s34, s34, 81920
    s_add_u32 s35, s35, 196608
    s_barrier
    ds_read_b64_tr_b16 v[32:33], v11 offset:20480
    ds_read_b64_tr_b16 v[34:35], v11 offset:21760
    ds_read_b64_tr_b16 v[48:49], v12 offset:20480
    ds_read_b64_tr_b16 v[50:51], v12 offset:21760
    ds_read_b64_tr_b16 v[36:37], v11 offset:25600
    ds_read_b64_tr_b16 v[38:39], v11 offset:26880
    ds_read_b64_tr_b16 v[52:53], v12 offset:25600
    ds_read_b64_tr_b16 v[54:55], v12 offset:26880
    ds_read_b64_tr_b16 v[40:41], v11 offset:30720
    ds_read_b64_tr_b16 v[42:43], v11 offset:32000
    ds_read_b64_tr_b16 v[56:57], v12 offset:30720
    ds_read_b64_tr_b16 v[58:59], v12 offset:32000
    ds_read_b64_tr_b16 v[44:45], v11 offset:35840
    ds_read_b64_tr_b16 v[46:47], v11 offset:37120
    ds_read_b64_tr_b16 v[60:61], v12 offset:35840
    ds_read_b64_tr_b16 v[62:63], v12 offset:37120
    s_waitcnt lgkmcnt(12)
    v_mfma_f32_32x32x16_bf16 v[16:31], v[32:35], v[48:51], v[16:31]
    s_waitcnt lgkmcnt(8)
    v_mfma_f32_32x32x16_bf16 v[16:31], v[36:39], v[52:55], v[16:31]
    s_waitcnt lgkmcnt(4)
    v_mfma_f32_32x32x16_bf16 v[16:31], v[40:43], v[56:59], v[16:31]
    s_waitcnt lgkmcnt(0)
    v_mfma_f32_32x32x16_bf16 v[16:31], v[44:47], v[60:63], v[16:31]
    s_waitcnt vmcnt(28)
    ds_write_b128 v10, v[160:163] offset:0
    ds_write_b128 v10, v[164:167] offset:10240
    ds_write_b128 v10, v[168:171] offset:128
    ds_write_b128 v10, v[172:175] offset:10368
    s_waitcnt lgkmcnt(0)
    buffer_load_dwordx4 v[160:163], v6, s[8:11], s34 offen
    buffer_load_dwordx4 v[164:167], v7, s[8:11], s34 offen
    buffer_load_dwordx4 v[168:171], v8, s[12:15], s35 offen
    buffer_load_dwordx4 v[172:175], v9, s[12:15], s35 offen
    s_add_u32 s34, s34, 81920
    s_add_u32 s35, s35, 196608
    s_barrier
    ds_read_b64_tr_b16 v[32:33], v11 offset:0
    ds_read_b64_tr_b16 v[34:35], v11 offset:1280
    ds_read_b64_tr_b16 v[48:49], v12 offset:0
    ds_read_b64_tr_b16 v[50:51], v12 offset:1280
    ds_read_b64_tr_b16 v[36:37], v11 offset:5120
    ds_read_b64_tr_b16 v[38:39], v11 offset:6400
    ds_read_b64_tr_b16 v[52:53], v12 offset:5120
    ds_read_b64_tr_b16 v[54:55], v12 offset:6400
    ds_read_b64_tr_b16 v[40:41], v11 offset:10240
    ds_read_b64_tr_b16 v[42:43], v11 offset:11520
    ds_read_b64_tr_b16 v[56:57], v12 offset:10240
    ds_read_b64_tr_b16 v[58:59], v12 offset:11520
    ds_read_b64_tr_b16 v[44:45], v11 offset:15360
    ds_read_b64_tr_b16 v[46:47], v11 offset:16640
    ds_read_b64_tr_b16 v[60:61], v12 offset:15360
    ds_read_b64_tr_b16 v[62:63], v12 offset:16640
    s_waitcnt lgkmcnt(12)
    v_mfma_f32_32x32x16_bf16 v[16:31], v[32:35], v[48:51], v[16:31]
    s_waitcnt lgkmcnt(8)
    v_mfma_f32_32x32x16_bf16 v[16:31], v[36:39], v[52:55], v[16:31]
    s_waitcnt lgkmcnt(4)
    v_mfma_f32_32x32x16_bf16 v[16:31], v[40:43], v[56:59], v[16:31]
    s_waitcnt lgkmcnt(0)
    v_mfma_f32_32x32x16_bf16 v[16:31], v[44:47], v[60:63], v[16:31]
    s_waitcnt vmcnt(28)
    ds_write_b128 v10, v[176:179] offset:20480
    ds_write_b128 v10, v[180:183] offset:30720
    ds_write_b128 v10, v[184:187] offset:20608
    ds_write_b128 v10, v[188:191] offset:30848
    s_waitcnt lgkmcnt(0)
    buffer_load_dwordx4 v[176:179], v6, s[8:11], s34 offen
    buffer_load_dwordx4 v[180:183], v7, s[8:11], s34 offen
    buffer_load_dwordx4 v[184:187], v8, s[12:15], s35 offen
    buffer_load_dwordx4 v[188:191], v9, s[12:15], s35 offen
    s_add_u32 s34, s34, 81920
    s_add_u32 s35, s35, 196608
    s_barrier
    ds_read_b64_tr_b16 v[32:33], v11 offset:20480
    ds_read_b64_tr_b16 v[34:35], v11 offset:21760
    ds_read_b64_tr_b16 v[48:49], v12 offset:20480
    ds_read_b64_tr_b16 v[50:51], v12 offset:21760
    ds_read_b64_tr_b16 v[36:37], v11 offset:25600
    ds_read_b64_tr_b16 v[38:39], v11 offset:26880
    ds_read_b64_tr_b16 v[52:53], v12 offset:25600
    ds_read_b64_tr_b16 v[54:55], v12 offset:26880
    ds_read_b64_tr_b16 v[40:41], v11 offset:30720
    ds_read_b64_tr_b16 v[42:43], v11 offset:32000
    ds_read_b64_tr_b16 v[56:57], v12 offset:30720
    ds_read_b64_tr_b16 v[58:59], v12 offset:32000
    ds_read_b64_tr_b16 v[44:45], v11 offset:35840
    ds_read_b64_tr_b16 v[46:47], v11 offset:37120
    ds_read_b64_tr_b16 v[60:61], v12 offset:35840
    ds_read_b64_tr_b16 v[62:63], v12 offset:37120
    s_waitcnt lgkmcnt(12)
    v_mfma_f32_32x32x16_bf16 v[16:31], v[32:35], v[48:51], v[16:31]
    s_waitcnt lgkmcnt(8)
    v_mfma_f32_32x32x16_bf16 v[16:31], v[36:39], v[52:55], v[16:31]
    s_waitcnt lgkmcnt(4)
    v_mfma_f32_32x32x16_bf16 v[16:31], v[40:43], v[56:59], v[16:31]
    s_waitcnt lgkmcnt(0)
    v_mfma_f32_32x32x16_bf16 v[16:31], v[44:47], v[60:63], v[16:31]
    s_waitcnt vmcnt(28)
    ds_write_b128 v10, v[64:67] offset:0
    ds_write_b128 v10, v[68:71] offset:10240
    ds_write_b128 v10, v[72:75] offset:128
    ds_write_b128 v10, v[76:79] offset:10368
    s_waitcnt lgkmcnt(0)
    buffer_load_dwordx4 v[64:67], v6, s[8:11], s34 offen
    buffer_load_dwordx4 v[68:71], v7, s[8:11], s34 offen
    buffer_load_dwordx4 v[72:75], v8, s[12:15], s35 offen
    buffer_load_dwordx4 v[76:79], v9, s[12:15], s35 offen
    s_add_u32 s34, s34, 81920
    s_add_u32 s35, s35, 196608
    s_barrier
    ds_read_b64_tr_b16 v[32:33], v11 offset:0
    ds_read_b64_tr_b16 v[34:35], v11 offset:1280
    ds_read_b64_tr_b16 v[48:49], v12 offset:0
    ds_read_b64_tr_b16 v[50:51], v12 offset:1280
    ds_read_b64_tr_b16 v[36:37], v11 offset:5120
    ds_read_b64_tr_b16 v[38:39], v11 offset:6400
    ds_read_b64_tr_b16 v[52:53], v12 offset:5120
    ds_read_b64_tr_b16 v[54:55], v12 offset:6400
    ds_read_b64_tr_b16 v[40:41], v11 offset:10240
    ds_read_b64_tr_b16 v[42:43], v11 offset:11520
    ds_read_b64_tr_b16 v[56:57], v12 offset:10240
    ds_read_b64_tr_b16 v[58:59], v12 offset:11520
    ds_read_b64_tr_b16 v[44:45], v11 offset:15360
    ds_read_b64_tr_b16 v[46:47], v11 offset:16640
    ds_read_b64_tr_b16 v[60:61], v12 offset:15360
    ds_read_b64_tr_b16 v[62:63], v12 offset:16640
    s_waitcnt lgkmcnt(12)
    v_mfma_f32_32x32x16_bf16 v[16:31], v[32:35], v[48:51], v[16:31]
    s_waitcnt lgkmcnt(8)
    v_mfma_f32_32x32x16_bf16 v[16:31], v[36:39], v[52:55], v[16:31]
    s_waitcnt lgkmcnt(4)
    v_mfma_f32_32x32x16_bf16 v[16:31], v[40:43], v[56:59], v[16:31]
    s_waitcnt lgkmcnt(0)
    v_mfma_f32_32x32x16_bf16 v[16:31], v[44:47], v[60:63], v[16:31]
    s_waitcnt vmcnt(28)
    ds_write_b128 v10, v[80:83] offset:20480
    ds_write_b128 v10, v[84:87] offset:30720
    ds_write_b128 v10, v[88:91] offset:20608
    ds_write_b128 v10, v[92:95] offset:30848
    s_waitcnt lgkmcnt(0)
    buffer_load_dwordx4 v[80:83], v6, s[8:11], s34 offen
    buffer_load_dwordx4 v[84:87], v7, s[8:11], s34 offen
    buffer_load_dwordx4 v[88:91], v8, s[12:15], s35 offen
    buffer_load_dwordx4 v[92:95], v9, s[12:15], s35 offen
    s_add_u32 s34, s34, 81920
    s_add_u32 s35, s35, 196608
    s_barrier
    ds_read_b64_tr_b16 v[32:33], v11 offset:20480
    ds_read_b64_tr_b16 v[34:35], v11 offset:21760
    ds_read_b64_tr_b16 v[48:49], v12 offset:20480
    ds_read_b64_tr_b16 v[50:51], v12 offset:21760
    ds_read_b64_tr_b16 v[36:37], v11 offset:25600
    ds_read_b64_tr_b16 v[38:39], v11 offset:26880
    ds_read_b64_tr_b16 v[52:53], v12 offset:25600
    ds_read_b64_tr_b16 v[54:55], v12 offset:26880
    ds_read_b64_tr_b16 v[40:41], v11 offset:30720
    ds_read_b64_tr_b16 v[42:43], v11 offset:32000
    ds_read_b64_tr_b16 v[56:57], v12 offset:30720
    ds_read_b64_tr_b16 v[58:59], v12 offset:32000
    ds_read_b64_tr_b16 v[44:45], v11 offset:35840
    ds_read_b64_tr_b16 v[46:47], v11 offset:37120
    ds_read_b64_tr_b16 v[60:61], v12 offset:35840
    ds_read_b64_tr_b16 v[62:63], v12 offset:37120
    s_waitcnt lgkmcnt(12)
    v_mfma_f32_32x32x16_bf16 v[16:31], v[32:35], v[48:51], v[16:31]
    s_waitcnt lgkmcnt(8)
    v_mfma_f32_32x32x16_bf16 v[16:31], v[36:39], v[52:55], v[16:31]
    s_waitcnt lgkmcnt(4)
    v_mfma_f32_32x32x16_bf16 v[16:31], v[40:43], v[56:59], v[16:31]
    s_waitcnt lgkmcnt(0)
    v_mfma_f32_32x32x16_bf16 v[16:31], v[44:47], v[60:63], v[16:31]
    s_waitcnt vmcnt(28)
    ds_write_b128 v10, v[96:99] offset:0
    ds_write_b128 v10, v[100:103] offset:10240
    ds_write_b128 v10, v[104:107] offset:128
    ds_write_b128 v10, v[108:111] offset:10368
    s_waitcnt lgkmcnt(0)
    buffer_load_dwordx4 v[96:99], v6, s[8:11], s34 offen
    buffer_load_dwordx4 v[100:103], v7, s[8:11], s34 offen
    buffer_load_dwordx4 v[104:107], v8, s[12:15], s35 offen
    buffer_load_dwordx4 v[108:111], v9, s[12:15], s35 offen
    s_add_u32 s34, s34, 81920
    s_add_u32 s35, s35, 196608
    s_barrier
    ds_read_b64_tr_b16 v[32:33], v11 offset:0
    ds_read_b64_tr_b16 v[34:35], v11 offset:1280
    ds_read_b64_tr_b16 v[48:49], v12 offset:0
    ds_read_b64_tr_b16 v[50:51], v12 offset:1280
    ds_read_b64_tr_b16 v[36:37], v11 offset:5120
    ds_read_b64_tr_b16 v[38:39], v11 offset:6400
    ds_read_b64_tr_b16 v[52:53], v12 offset:5120
    ds_read_b64_tr_b16 v[54:55], v12 offset:6400
    ds_read_b64_tr_b16 v[40:41], v11 offset:10240
    ds_read_b64_tr_b16 v[42:43], v11 offset:11520
    ds_read_b64_tr_b16 v[56:57], v12 offset:10240
    ds_read_b64_tr_b16 v[58:59], v12 offset:11520
    ds_read_b64_tr_b16 v[44:45], v11 offset:15360
    ds_read_b64_tr_b16 v[46:47], v11 offset:16640
    ds_read_b64_tr_b16 v[60:61], v12 offset:15360
    ds_read_b64_tr_b16 v[62:63], v12 offset:16640
    s_waitcnt lgkmcnt(12)
    v_mfma_f32_32x32x16_bf16 v[16:31], v[32:35], v[48:51], v[16:31]
    s_waitcnt lgkmcnt(8)
    v_mfma_f32_32x32x16_bf16 v[16:31], v[36:39], v[52:55], v[16:31]
    s_waitcnt lgkmcnt(4)
    v_mfma_f32_32x32x16_bf16 v[16:31], v[40:43], v[56:59], v[16:31]
    s_waitcnt lgkmcnt(0)
    v_mfma_f32_32x32x16_bf16 v[16:31], v[44:47], v[60:63], v[16:31]
    s_waitcnt vmcnt(28)
    ds_write_b128 v10, v[112:115] offset:20480
    ds_write_b128 v10, v[116:119] offset:30720
    ds_write_b128 v10, v[120:123] offset:20608
    ds_write_b128 v10, v[124:127] offset:30848
    s_waitcnt lgkmcnt(0)
    buffer_load_dwordx4 v[112:115], v6, s[8:11], s34 offen
    buffer_load_dwordx4 v[116:119], v7, s[8:11], s34 offen
    buffer_load_dwordx4 v[120:123], v8, s[12:15], s35 offen
    buffer_load_dwordx4 v[124:127], v9, s[12:15], s35 offen
    s_add_u32 s34, s34, 81920
    s_add_u32 s35, s35, 196608
    s_barrier
    ds_read_b64_tr_b16 v[32:33], v11 offset:20480
    ds_read_b64_tr_b16 v[34:35], v11 offset:21760
    ds_read_b64_tr_b16 v[48:49], v12 offset:20480
    ds_read_b64_tr_b16 v[50:51], v12 offset:21760
    ds_read_b64_tr_b16 v[36:37], v11 offset:25600
    ds_read_b64_tr_b16 v[38:39], v11 offset:26880
    ds_read_b64_tr_b16 v[52:53], v12 offset:25600
    ds_read_b64_tr_b16 v[54:55], v12 offset:26880
    ds_read_b64_tr_b16 v[40:41], v11 offset:30720
    ds_read_b64_tr_b16 v[42:43], v11 offset:32000
    ds_read_b64_tr_b16 v[56:57], v12 offset:30720
    ds_read_b64_tr_b16 v[58:59], v12 offset:32000
    ds_read_b64_tr_b16 v[44:45], v11 offset:35840
    ds_read_b64_tr_b16 v[46:47], v11 offset:37120
    ds_read_b64_tr_b16 v[60:61], v12 offset:35840
    ds_read_b64_tr_b16 v[62:63], v12 offset:37120
    s_waitcnt lgkmcnt(12)
    v_mfma_f32_32x32x16_bf16 v[16:31], v[32:35], v[48:51], v[16:31]
    s_waitcnt lgkmcnt(8)
    v_mfma_f32_32x32x16_bf16 v[16:31], v[36:39], v[52:55], v[16:31]
    s_waitcnt lgkmcnt(4)
    v_mfma_f32_32x32x16_bf16 v[16:31], v[40:43], v[56:59], v[16:31]
    s_waitcnt lgkmcnt(0)
    v_mfma_f32_32x32x16_bf16 v[16:31], v[44:47], v[60:63], v[16:31]
    s_waitcnt vmcnt(28)
    ds_write_b128 v10, v[128:131] offset:0
    ds_write_b128 v10, v[132:135] offset:10240
    ds_write_b128 v10, v[136:139] offset:128
    ds_write_b128 v10, v[140:143] offset:10368
    s_waitcnt lgkmcnt(0)
    buffer_load_dwordx4 v[128:131], v6, s[8:11], s34 offen
    buffer_load_dwordx4 v[132:135], v7, s[8:11], s34 offen
    buffer_load_dwordx4 v[136:139], v8, s[12:15], s35 offen
    buffer_load_dwordx4 v[140:143], v9, s[12:15], s35 offen
    s_add_u32 s34, s34, 81920
    s_add_u32 s35, s35, 196608
    s_barrier
    ds_read_b64_tr_b16 v[32:33], v11 offset:0
    ds_read_b64_tr_b16 v[34:35], v11 offset:1280
    ds_read_b64_tr_b16 v[48:49], v12 offset:0
    ds_read_b64_tr_b16 v[50:51], v12 offset:1280
    ds_read_b64_tr_b16 v[36:37], v11 offset:5120
    ds_read_b64_tr_b16 v[38:39], v11 offset:6400
    ds_read_b64_tr_b16 v[52:53], v12 offset:5120
    ds_read_b64_tr_b16 v[54:55], v12 offset:6400
    ds_read_b64_tr_b16 v[40:41], v11 offset:10240
    ds_read_b64_tr_b16 v[42:43], v11 offset:11520
    ds_read_b64_tr_b16 v[56:57], v12 offset:10240
    ds_read_b64_tr_b16 v[58:59], v12 offset:11520
    ds_read_b64_tr_b16 v[44:45], v11 offset:15360
    ds_read_b64_tr_b16 v[46:47], v11 offset:16640
    ds_read_b64_tr_b16 v[60:61], v12 offset:15360
    ds_read_b64_tr_b16 v[62:63], v12 offset:16640
    s_waitcnt lgkmcnt(12)
    v_mfma_f32_32x32x16_bf16 v[16:31], v[32:35], v[48:51], v[16:31]
    s_waitcnt lgkmcnt(8)
    v_mfma_f32_32x32x16_bf16 v[16:31], v[36:39], v[52:55], v[16:31]
    s_waitcnt lgkmcnt(4)
    v_mfma_f32_32x32x16_bf16 v[16:31], v[40:43], v[56:59], v[16:31]
    s_waitcnt lgkmcnt(0)
    v_mfma_f32_32x32x16_bf16 v[16:31], v[44:47], v[60:63], v[16:31]
    s_waitcnt vmcnt(28)
    ds_write_b128 v10, v[144:147] offset:20480
    ds_write_b128 v10, v[148:151] offset:30720
    ds_write_b128 v10, v[152:155] offset:20608
    ds_write_b128 v10, v[156:159] offset:30848
    s_waitcnt lgkmcnt(0)
    buffer_load_dwordx4 v[144:147], v6, s[8:11], s34 offen
    buffer_load_dwordx4 v[148:151], v7, s[8:11], s34 offen
    buffer_load_dwordx4 v[152:155], v8, s[12:15], s35 offen
    buffer_load_dwordx4 v[156:159], v9, s[12:15], s35 offen
    s_add_u32 s34, s34, 81920
    s_add_u32 s35, s35, 196608
    s_barrier
    ds_read_b64_tr_b16 v[32:33], v11 offset:20480
    ds_read_b64_tr_b16 v[34:35], v11 offset:21760
    ds_read_b64_tr_b16 v[48:49], v12 offset:20480
    ds_read_b64_tr_b16 v[50:51], v12 offset:21760
    ds_read_b64_tr_b16 v[36:37], v11 offset:25600
    ds_read_b64_tr_b16 v[38:39], v11 offset:26880
    ds_read_b64_tr_b16 v[52:53], v12 offset:25600
    ds_read_b64_tr_b16 v[54:55], v12 offset:26880
    ds_read_b64_tr_b16 v[40:41], v11 offset:30720
    ds_read_b64_tr_b16 v[42:43], v11 offset:32000
    ds_read_b64_tr_b16 v[56:57], v12 offset:30720
    ds_read_b64_tr_b16 v[58:59], v12 offset:32000
    ds_read_b64_tr_b16 v[44:45], v11 offset:35840
    ds_read_b64_tr_b16 v[46:47], v11 offset:37120
    ds_read_b64_tr_b16 v[60:61], v12 offset:35840
    ds_read_b64_tr_b16 v[62:63], v12 offset:37120
    s_waitcnt lgkmcnt(12)
    v_mfma_f32_32x32x16_bf16 v[16:31], v[32:35], v[48:51], v[16:31]
    s_waitcnt lgkmcnt(8)
    v_mfma_f32_32x32x16_bf16 v[16:31], v[36:39], v[52:55], v[16:31]
    s_waitcnt lgkmcnt(4)
    v_mfma_f32_32x32x16_bf16 v[16:31], v[40:43], v[56:59], v[16:31]
    s_waitcnt lgkmcnt(0)
    v_mfma_f32_32x32x16_bf16 v[16:31], v[44:47], v[60:63], v[16:31]
    s_waitcnt vmcnt(28)
    ds_write_b128 v10, v[160:163] offset:0
    ds_write_b128 v10, v[164:167] offset:10240
    ds_write_b128 v10, v[168:171] offset:128
    ds_write_b128 v10, v[172:175] offset:10368
    s_waitcnt lgkmcnt(0)
    buffer_load_dwordx4 v[160:163], v6, s[8:11], s34 offen
    buffer_load_dwordx4 v[164:167], v7, s[8:11], s34 offen
    buffer_load_dwordx4 v[168:171], v8, s[12:15], s35 offen
    buffer_load_dwordx4 v[172:175], v9, s[12:15], s35 offen
    s_add_u32 s34, s34, 81920
    s_add_u32 s35, s35, 196608
    s_barrier
    ds_read_b64_tr_b16 v[32:33], v11 offset:0
    ds_read_b64_tr_b16 v[34:35], v11 offset:1280
    ds_read_b64_tr_b16 v[48:49], v12 offset:0
    ds_read_b64_tr_b16 v[50:51], v12 offset:1280
    ds_read_b64_tr_b16 v[36:37], v11 offset:5120
    ds_read_b64_tr_b16 v[38:39], v11 offset:6400
    ds_read_b64_tr_b16 v[52:53], v12 offset:5120
    ds_read_b64_tr_b16 v[54:55], v12 offset:6400
    ds_read_b64_tr_b16 v[40:41], v11 offset:10240
    ds_read_b64_tr_b16 v[42:43], v11 offset:11520
    ds_read_b64_tr_b16 v[56:57], v12 offset:10240
    ds_read_b64_tr_b16 v[58:59], v12 offset:11520
    ds_read_b64_tr_b16 v[44:45], v11 offset:15360
    ds_read_b64_tr_b16 v[46:47], v11 offset:16640
    ds_read_b64_tr_b16 v[60:61], v12 offset:15360
    ds_read_b64_tr_b16 v[62:63], v12 offset:16640
    s_waitcnt lgkmcnt(12)
    v_mfma_f32_32x32x16_bf16 v[16:31], v[32:35], v[48:51], v[16:31]
    s_waitcnt lgkmcnt(8)
    v_mfma_f32_32x32x16_bf16 v[16:31], v[36:39], v[52:55], v[16:31]
    s_waitcnt lgkmcnt(4)
    v_mfma_f32_32x32x16_bf16 v[16:31], v[40:43], v[56:59], v[16:31]
    s_waitcnt lgkmcnt(0)
    v_mfma_f32_32x32x16_bf16 v[16:31], v[44:47], v[60:63], v[16:31]
    s_waitcnt vmcnt(28)
    ds_write_b128 v10, v[176:179] offset:20480
    ds_write_b128 v10, v[180:183] offset:30720
    ds_write_b128 v10, v[184:187] offset:20608
    ds_write_b128 v10, v[188:191] offset:30848
    s_waitcnt lgkmcnt(0)
    buffer_load_dwordx4 v[176:179], v6, s[8:11], s34 offen
    buffer_load_dwordx4 v[180:183], v7, s[8:11], s34 offen
    buffer_load_dwordx4 v[184:187], v8, s[12:15], s35 offen
    buffer_load_dwordx4 v[188:191], v9, s[12:15], s35 offen
    s_add_u32 s34, s34, 81920
    s_add_u32 s35, s35, 196608
    s_barrier
    ds_read_b64_tr_b16 v[32:33], v11 offset:20480
    ds_read_b64_tr_b16 v[34:35], v11 offset:21760
    ds_read_b64_tr_b16 v[48:49], v12 offset:20480
    ds_read_b64_tr_b16 v[50:51], v12 offset:21760
    ds_read_b64_tr_b16 v[36:37], v11 offset:25600
    ds_read_b64_tr_b16 v[38:39], v11 offset:26880
    ds_read_b64_tr_b16 v[52:53], v12 offset:25600
    ds_read_b64_tr_b16 v[54:55], v12 offset:26880
    ds_read_b64_tr_b16 v[40:41], v11 offset:30720
    ds_read_b64_tr_b16 v[42:43], v11 offset:32000
    ds_read_b64_tr_b16 v[56:57], v12 offset:30720
    ds_read_b64_tr_b16 v[58:59], v12 offset:32000
    ds_read_b64_tr_b16 v[44:45], v11 offset:35840
    ds_read_b64_tr_b16 v[46:47], v11 offset:37120
    ds_read_b64_tr_b16 v[60:61], v12 offset:35840
    ds_read_b64_tr_b16 v[62:63], v12 offset:37120
    s_waitcnt lgkmcnt(12)
    v_mfma_f32_32x32x16_bf16 v[16:31], v[32:35], v[48:51], v[16:31]
    s_waitcnt lgkmcnt(8)
    v_mfma_f32_32x32x16_bf16 v[16:31], v[36:39], v[52:55], v[16:31]
    s_waitcnt lgkmcnt(4)
    v_mfma_f32_32x32x16_bf16 v[16:31], v[40:43], v[56:59], v[16:31]
    s_waitcnt lgkmcnt(0)
    v_mfma_f32_32x32x16_bf16 v[16:31], v[44:47], v[60:63], v[16:31]
    s_waitcnt vmcnt(28)
    ds_write_b128 v10, v[64:67] offset:0
    ds_write_b128 v10, v[68:71] offset:10240
    ds_write_b128 v10, v[72:75] offset:128
    ds_write_b128 v10, v[76:79] offset:10368
    s_waitcnt lgkmcnt(0)
    s_barrier
    ds_read_b64_tr_b16 v[32:33], v11 offset:0
    ds_read_b64_tr_b16 v[34:35], v11 offset:1280
    ds_read_b64_tr_b16 v[48:49], v12 offset:0
    ds_read_b64_tr_b16 v[50:51], v12 offset:1280
    ds_read_b64_tr_b16 v[36:37], v11 offset:5120
    ds_read_b64_tr_b16 v[38:39], v11 offset:6400
    ds_read_b64_tr_b16 v[52:53], v12 offset:5120
    ds_read_b64_tr_b16 v[54:55], v12 offset:6400
    ds_read_b64_tr_b16 v[40:41], v11 offset:10240
    ds_read_b64_tr_b16 v[42:43], v11 offset:11520
    ds_read_b64_tr_b16 v[56:57], v12 offset:10240
    ds_read_b64_tr_b16 v[58:59], v12 offset:11520
    ds_read_b64_tr_b16 v[44:45], v11 offset:15360
    ds_read_b64_tr_b16 v[46:47], v11 offset:16640
    ds_read_b64_tr_b16 v[60:61], v12 offset:15360
    ds_read_b64_tr_b16 v[62:63], v12 offset:16640
    s_waitcnt lgkmcnt(12)
    v_mfma_f32_32x32x16_bf16 v[16:31], v[32:35], v[48:51], v[16:31]
    s_waitcnt lgkmcnt(8)
    v_mfma_f32_32x32x16_bf16 v[16:31], v[36:39], v[52:55], v[16:31]
    s_waitcnt lgkmcnt(4)
    v_mfma_f32_32x32x16_bf16 v[16:31], v[40:43], v[56:59], v[16:31]
    s_waitcnt lgkmcnt(0)
    v_mfma_f32_32x32x16_bf16 v[16:31], v[44:47], v[60:63], v[16:31]
    s_waitcnt vmcnt(24)
    ds_write_b128 v10, v[80:83] offset:20480
    ds_write_b128 v10, v[84:87] offset:30720
    ds_write_b128 v10, v[88:91] offset:20608
    ds_write_b128 v10, v[92:95] offset:30848
    s_waitcnt lgkmcnt(0)
    s_barrier
    ds_read_b64_tr_b16 v[32:33], v11 offset:20480
    ds_read_b64_tr_b16 v[34:35], v11 offset:21760
    ds_read_b64_tr_b16 v[48:49], v12 offset:20480
    ds_read_b64_tr_b16 v[50:51], v12 offset:21760
    ds_read_b64_tr_b16 v[36:37], v11 offset:25600
    ds_read_b64_tr_b16 v[38:39], v11 offset:26880
    ds_read_b64_tr_b16 v[52:53], v12 offset:25600
    ds_read_b64_tr_b16 v[54:55], v12 offset:26880
    ds_read_b64_tr_b16 v[40:41], v11 offset:30720
    ds_read_b64_tr_b16 v[42:43], v11 offset:32000
    ds_read_b64_tr_b16 v[56:57], v12 offset:30720
    ds_read_b64_tr_b16 v[58:59], v12 offset:32000
    ds_read_b64_tr_b16 v[44:45], v11 offset:35840
    ds_read_b64_tr_b16 v[46:47], v11 offset:37120
    ds_read_b64_tr_b16 v[60:61], v12 offset:35840
    ds_read_b64_tr_b16 v[62:63], v12 offset:37120
    s_waitcnt lgkmcnt(12)
    v_mfma_f32_32x32x16_bf16 v[16:31], v[32:35], v[48:51], v[16:31]
    s_waitcnt lgkmcnt(8)
    v_mfma_f32_32x32x16_bf16 v[16:31], v[36:39], v[52:55], v[16:31]
    s_waitcnt lgkmcnt(4)
    v_mfma_f32_32x32x16_bf16 v[16:31], v[40:43], v[56:59], v[16:31]
    s_waitcnt lgkmcnt(0)
    v_mfma_f32_32x32x16_bf16 v[16:31], v[44:47], v[60:63], v[16:31]
    s_waitcnt vmcnt(20)
    ds_write_b128 v10, v[96:99] offset:0
    ds_write_b128 v10, v[100:103] offset:10240
    ds_write_b128 v10, v[104:107] offset:128
    ds_write_b128 v10, v[108:111] offset:10368
    s_waitcnt lgkmcnt(0)
    s_barrier
    ds_read_b64_tr_b16 v[32:33], v11 offset:0
    ds_read_b64_tr_b16 v[34:35], v11 offset:1280
    ds_read_b64_tr_b16 v[48:49], v12 offset:0
    ds_read_b64_tr_b16 v[50:51], v12 offset:1280
    ds_read_b64_tr_b16 v[36:37], v11 offset:5120
    ds_read_b64_tr_b16 v[38:39], v11 offset:6400
    ds_read_b64_tr_b16 v[52:53], v12 offset:5120
    ds_read_b64_tr_b16 v[54:55], v12 offset:6400
    ds_read_b64_tr_b16 v[40:41], v11 offset:10240
    ds_read_b64_tr_b16 v[42:43], v11 offset:11520
    ds_read_b64_tr_b16 v[56:57], v12 offset:10240
    ds_read_b64_tr_b16 v[58:59], v12 offset:11520
    ds_read_b64_tr_b16 v[44:45], v11 offset:15360
    ds_read_b64_tr_b16 v[46:47], v11 offset:16640
    ds_read_b64_tr_b16 v[60:61], v12 offset:15360
    ds_read_b64_tr_b16 v[62:63], v12 offset:16640
    s_waitcnt lgkmcnt(12)
    v_mfma_f32_32x32x16_bf16 v[16:31], v[32:35], v[48:51], v[16:31]
    s_waitcnt lgkmcnt(8)
    v_mfma_f32_32x32x16_bf16 v[16:31], v[36:39], v[52:55], v[16:31]
    s_waitcnt lgkmcnt(4)
    v_mfma_f32_32x32x16_bf16 v[16:31], v[40:43], v[56:59], v[16:31]
    s_waitcnt lgkmcnt(0)
    v_mfma_f32_32x32x16_bf16 v[16:31], v[44:47], v[60:63], v[16:31]
    s_waitcnt vmcnt(16)
    ds_write_b128 v10, v[112:115] offset:20480
    ds_write_b128 v10, v[116:119] offset:30720
    ds_write_b128 v10, v[120:123] offset:20608
    ds_write_b128 v10, v[124:127] offset:30848
    s_waitcnt lgkmcnt(0)
    s_barrier
    ds_read_b64_tr_b16 v[32:33], v11 offset:20480
    ds_read_b64_tr_b16 v[34:35], v11 offset:21760
    ds_read_b64_tr_b16 v[48:49], v12 offset:20480
    ds_read_b64_tr_b16 v[50:51], v12 offset:21760
    ds_read_b64_tr_b16 v[36:37], v11 offset:25600
    ds_read_b64_tr_b16 v[38:39], v11 offset:26880
    ds_read_b64_tr_b16 v[52:53], v12 offset:25600
    ds_read_b64_tr_b16 v[54:55], v12 offset:26880
    ds_read_b64_tr_b16 v[40:41], v11 offset:30720
    ds_read_b64_tr_b16 v[42:43], v11 offset:32000
    ds_read_b64_tr_b16 v[56:57], v12 offset:30720
    ds_read_b64_tr_b16 v[58:59], v12 offset:32000
    ds_read_b64_tr_b16 v[44:45], v11 offset:35840
    ds_read_b64_tr_b16 v[46:47], v11 offset:37120
    ds_read_b64_tr_b16 v[60:61], v12 offset:35840
    ds_read_b64_tr_b16 v[62:63], v12 offset:37120
    s_waitcnt lgkmcnt(12)
    v_mfma_f32_32x32x16_bf16 v[16:31], v[32:35], v[48:51], v[16:31]
    s_waitcnt lgkmcnt(8)
    v_mfma_f32_32x32x16_bf16 v[16:31], v[36:39], v[52:55], v[16:31]
    s_waitcnt lgkmcnt(4)
    v_mfma_f32_32x32x16_bf16 v[16:31], v[40:43], v[56:59], v[16:31]
    s_waitcnt lgkmcnt(0)
    v_mfma_f32_32x32x16_bf16 v[16:31], v[44:47], v[60:63], v[16:31]
    s_waitcnt vmcnt(12)
    ds_write_b128 v10, v[128:131] offset:0
    ds_write_b128 v10, v[132:135] offset:10240
    ds_write_b128 v10, v[136:139] offset:128
    ds_write_b128 v10, v[140:143] offset:10368
    s_waitcnt lgkmcnt(0)
    s_barrier
    ds_read_b64_tr_b16 v[32:33], v11 offset:0
    ds_read_b64_tr_b16 v[34:35], v11 offset:1280
    ds_read_b64_tr_b16 v[48:49], v12 offset:0
    ds_read_b64_tr_b16 v[50:51], v12 offset:1280
    ds_read_b64_tr_b16 v[36:37], v11 offset:5120
    ds_read_b64_tr_b16 v[38:39], v11 offset:6400
    ds_read_b64_tr_b16 v[52:53], v12 offset:5120
    ds_read_b64_tr_b16 v[54:55], v12 offset:6400
    ds_read_b64_tr_b16 v[40:41], v11 offset:10240
    ds_read_b64_tr_b16 v[42:43], v11 offset:11520
    ds_read_b64_tr_b16 v[56:57], v12 offset:10240
    ds_read_b64_tr_b16 v[58:59], v12 offset:11520
    ds_read_b64_tr_b16 v[44:45], v11 offset:15360
    ds_read_b64_tr_b16 v[46:47], v11 offset:16640
    ds_read_b64_tr_b16 v[60:61], v12 offset:15360
    ds_read_b64_tr_b16 v[62:63], v12 offset:16640
    s_waitcnt lgkmcnt(12)
    v_mfma_f32_32x32x16_bf16 v[16:31], v[32:35], v[48:51], v[16:31]
    s_waitcnt lgkmcnt(8)
    v_mfma_f32_32x32x16_bf16 v[16:31], v[36:39], v[52:55], v[16:31]
    s_waitcnt lgkmcnt(4)
    v_mfma_f32_32x32x16_bf16 v[16:31], v[40:43], v[56:59], v[16:31]
    s_waitcnt lgkmcnt(0)
    v_mfma_f32_32x32x16_bf16 v[16:31], v[44:47], v[60:63], v[16:31]
    s_waitcnt vmcnt(8)
    ds_write_b128 v10, v[144:147] offset:20480
    ds_write_b128 v10, v[148:151] offset:30720
    ds_write_b128 v10, v[152:155] offset:20608
    ds_write_b128 v10, v[156:159] offset:30848
    s_waitcnt lgkmcnt(0)
    s_barrier
    ds_read_b64_tr_b16 v[32:33], v11 offset:20480
    ds_read_b64_tr_b16 v[34:35], v11 offset:21760
    ds_read_b64_tr_b16 v[48:49], v12 offset:20480
    ds_read_b64_tr_b16 v[50:51], v12 offset:21760
    ds_read_b64_tr_b16 v[36:37], v11 offset:25600
    ds_read_b64_tr_b16 v[38:39], v11 offset:26880
    ds_read_b64_tr_b16 v[52:53], v12 offset:25600
    ds_read_b64_tr_b16 v[54:55], v12 offset:26880
    ds_read_b64_tr_b16 v[40:41], v11 offset:30720
    ds_read_b64_tr_b16 v[42:43], v11 offset:32000
    ds_read_b64_tr_b16 v[56:57], v12 offset:30720
    ds_read_b64_tr_b16 v[58:59], v12 offset:32000
    ds_read_b64_tr_b16 v[44:45], v11 offset:35840
    ds_read_b64_tr_b16 v[46:47], v11 offset:37120
    ds_read_b64_tr_b16 v[60:61], v12 offset:35840
    ds_read_b64_tr_b16 v[62:63], v12 offset:37120
    s_waitcnt lgkmcnt(12)
    v_mfma_f32_32x32x16_bf16 v[16:31], v[32:35], v[48:51], v[16:31]
    s_waitcnt lgkmcnt(8)
    v_mfma_f32_32x32x16_bf16 v[16:31], v[36:39], v[52:55], v[16:31]
    s_waitcnt lgkmcnt(4)
    v_mfma_f32_32x32x16_bf16 v[16:31], v[40:43], v[56:59], v[16:31]
    s_waitcnt lgkmcnt(0)
    v_mfma_f32_32x32x16_bf16 v[16:31], v[44:47], v[60:63], v[16:31]
    s_waitcnt vmcnt(4)
    ds_write_b128 v10, v[160:163] offset:0
    ds_write_b128 v10, v[164:167] offset:10240
    ds_write_b128 v10, v[168:171] offset:128
    ds_write_b128 v10, v[172:175] offset:10368
    s_waitcnt lgkmcnt(0)
    s_barrier
    ds_read_b64_tr_b16 v[32:33], v11 offset:0
    ds_read_b64_tr_b16 v[34:35], v11 offset:1280
    ds_read_b64_tr_b16 v[48:49], v12 offset:0
    ds_read_b64_tr_b16 v[50:51], v12 offset:1280
    ds_read_b64_tr_b16 v[36:37], v11 offset:5120
    ds_read_b64_tr_b16 v[38:39], v11 offset:6400
    ds_read_b64_tr_b16 v[52:53], v12 offset:5120
    ds_read_b64_tr_b16 v[54:55], v12 offset:6400
    ds_read_b64_tr_b16 v[40:41], v11 offset:10240
    ds_read_b64_tr_b16 v[42:43], v11 offset:11520
    ds_read_b64_tr_b16 v[56:57], v12 offset:10240
    ds_read_b64_tr_b16 v[58:59], v12 offset:11520
    ds_read_b64_tr_b16 v[44:45], v11 offset:15360
    ds_read_b64_tr_b16 v[46:47], v11 offset:16640
    ds_read_b64_tr_b16 v[60:61], v12 offset:15360
    ds_read_b64_tr_b16 v[62:63], v12 offset:16640
    s_waitcnt lgkmcnt(12)
    v_mfma_f32_32x32x16_bf16 v[16:31], v[32:35], v[48:51], v[16:31]
    s_waitcnt lgkmcnt(8)
    v_mfma_f32_32x32x16_bf16 v[16:31], v[36:39], v[52:55], v[16:31]
    s_waitcnt lgkmcnt(4)
    v_mfma_f32_32x32x16_bf16 v[16:31], v[40:43], v[56:59], v[16:31]
    s_waitcnt lgkmcnt(0)
    v_mfma_f32_32x32x16_bf16 v[16:31], v[44:47], v[60:63], v[16:31]
    s_waitcnt vmcnt(0)
    ds_write_b128 v10, v[176:179] offset:20480
    ds_write_b128 v10, v[180:183] offset:30720
    ds_write_b128 v10, v[184:187] offset:20608
    ds_write_b128 v10, v[188:191] offset:30848
    s_waitcnt lgkmcnt(0)
    s_barrier
    ds_read_b64_tr_b16 v[32:33], v11 offset:20480
    ds_read_b64_tr_b16 v[34:35], v11 offset:21760
    ds_read_b64_tr_b16 v[48:49], v12 offset:20480
    ds_read_b64_tr_b16 v[50:51], v12 offset:21760
    ds_read_b64_tr_b16 v[36:37], v11 offset:25600
    ds_read_b64_tr_b16 v[38:39], v11 offset:26880
    ds_read_b64_tr_b16 v[52:53], v12 offset:25600
    ds_read_b64_tr_b16 v[54:55], v12 offset:26880
    ds_read_b64_tr_b16 v[40:41], v11 offset:30720
    ds_read_b64_tr_b16 v[42:43], v11 offset:32000
    ds_read_b64_tr_b16 v[56:57], v12 offset:30720
    ds_read_b64_tr_b16 v[58:59], v12 offset:32000
    ds_read_b64_tr_b16 v[44:45], v11 offset:35840
    ds_read_b64_tr_b16 v[46:47], v11 offset:37120
    ds_read_b64_tr_b16 v[60:61], v12 offset:35840
    ds_read_b64_tr_b16 v[62:63], v12 offset:37120
    s_waitcnt lgkmcnt(12)
    v_mfma_f32_32x32x16_bf16 v[16:31], v[32:35], v[48:51], v[16:31]
    s_waitcnt lgkmcnt(8)
    v_mfma_f32_32x32x16_bf16 v[16:31], v[36:39], v[52:55], v[16:31]
    s_waitcnt lgkmcnt(4)
    v_mfma_f32_32x32x16_bf16 v[16:31], v[40:43], v[56:59], v[16:31]
    s_waitcnt lgkmcnt(0)
    v_mfma_f32_32x32x16_bf16 v[16:31], v[44:47], v[60:63], v[16:31]
    s_nop 15
    v_and_b32 v3, 31, v1
    v_lshrrev_b32 v4, 1, v2
    v_lshlrev_b32 v4, 5, v4
    v_add_u32 v3, v3, v4
    v_lshlrev_b32 v5, 1, v3
    buffer_load_ushort v13, v5, s[20:23], s33 offen
    v_mul_u32_u24 v6, 1280, v3
    v_and_b32 v4, 1, v2
    v_lshlrev_b32 v4, 6, v4
    v_add_u32 v6, v6, v4
    v_lshrrev_b32 v4, 5, v1
    v_lshlrev_b32 v4, 3, v4
    v_add_u32 v6, v6, v4
    s_mul_i32 s36, s29, 81920
    s_add_u32 s36, s36, s32
    s_waitcnt vmcnt(0)
    v_lshlrev_b32 v13, 16, v13
    s_mov_b32 s37, 0xc0135761
    s_mov_b32 s38, 0xbdd2d3e8
    v_cvt_pk_bf16_f32 v14, v16, v16
    v_lshlrev_b32 v16, 16, v14
    v_add_f32 v16, v16, v13
    v_cvt_pk_bf16_f32 v14, v16, v16
    v_lshlrev_b32 v16, 16, v14
    v_mul_f32 v14, v16, v16
    v_mov_b32 v15, s37
    v_fma_f32 v14, v14, s38, v15
    v_mul_f32 v14, v14, v16
    v_exp_f32 v14, v14
    s_nop 0
    v_add_f32 v14, 1.0, v14
    v_rcp_f32 v14, v14
    s_nop 0
    v_mul_f32 v16, v16, v14
    v_cvt_pk_bf16_f32 v14, v17, v17
    v_lshlrev_b32 v17, 16, v14
    v_add_f32 v17, v17, v13
    v_cvt_pk_bf16_f32 v14, v17, v17
    v_lshlrev_b32 v17, 16, v14
    v_mul_f32 v14, v17, v17
    v_mov_b32 v15, s37
    v_fma_f32 v14, v14, s38, v15
    v_mul_f32 v14, v14, v17
    v_exp_f32 v14, v14
    s_nop 0
    v_add_f32 v14, 1.0, v14
    v_rcp_f32 v14, v14
    s_nop 0
    v_mul_f32 v17, v17, v14
    v_cvt_pk_bf16_f32 v14, v18, v18
    v_lshlrev_b32 v18, 16, v14
    v_add_f32 v18, v18, v13
    v_cvt_pk_bf16_f32 v14, v18, v18
    v_lshlrev_b32 v18, 16, v14
    v_mul_f32 v14, v18, v18
    v_mov_b32 v15, s37
    v_fma_f32 v14, v14, s38, v15
    v_mul_f32 v14, v14, v18
    v_exp_f32 v14, v14
    s_nop 0
    v_add_f32 v14, 1.0, v14
    v_rcp_f32 v14, v14
    s_nop 0
    v_mul_f32 v18, v18, v14
    v_cvt_pk_bf16_f32 v14, v19, v19
    v_lshlrev_b32 v19, 16, v14
    v_add_f32 v19, v19, v13
    v_cvt_pk_bf16_f32 v14, v19, v19
    v_lshlrev_b32 v19, 16, v14
    v_mul_f32 v14, v19, v19
    v_mov_b32 v15, s37
    v_fma_f32 v14, v14, s38, v15
    v_mul_f32 v14, v14, v19
    v_exp_f32 v14, v14
    s_nop 0
    v_add_f32 v14, 1.0, v14
    v_rcp_f32 v14, v14
    s_nop 0
    v_mul_f32 v19, v19, v14
    v_cvt_pk_bf16_f32 v14, v16, v17
    v_cvt_pk_bf16_f32 v15, v18, v19
    buffer_store_dwordx2 v[14:15], v6, s[16:19], s36 offen offset:0
    s_nop 1
    v_cvt_pk_bf16_f32 v14, v20, v20
    v_lshlrev_b32 v20, 16, v14
    v_add_f32 v20, v20, v13
    v_cvt_pk_bf16_f32 v14, v20, v20
    v_lshlrev_b32 v20, 16, v14
    v_mul_f32 v14, v20, v20
    v_mov_b32 v15, s37
    v_fma_f32 v14, v14, s38, v15
    v_mul_f32 v14, v14, v20
    v_exp_f32 v14, v14
    s_nop 0
    v_add_f32 v14, 1.0, v14
    v_rcp_f32 v14, v14
    s_nop 0
    v_mul_f32 v20, v20, v14
    v_cvt_pk_bf16_f32 v14, v21, v21
    v_lshlrev_b32 v21, 16, v14
    v_add_f32 v21, v21, v13
    v_cvt_pk_bf16_f32 v14, v21, v21
    v_lshlrev_b32 v21, 16, v14
    v_mul_f32 v14, v21, v21
    v_mov_b32 v15, s37
    v_fma_f32 v14, v14, s38, v15
    v_mul_f32 v14, v14, v21
    v_exp_f32 v14, v14
    s_nop 0
    v_add_f32 v14, 1.0, v14
    v_rcp_f32 v14, v14
    s_nop 0
    v_mul_f32 v21, v21, v14
    v_cvt_pk_bf16_f32 v14, v22, v22
    v_lshlrev_b32 v22, 16, v14
    v_add_f32 v22, v22, v13
    v_cvt_pk_bf16_f32 v14, v22, v22
    v_lshlrev_b32 v22, 16, v14
    v_mul_f32 v14, v22, v22
    v_mov_b32 v15, s37
    v_fma_f32 v14, v14, s38, v15
    v_mul_f32 v14, v14, v22
    v_exp_f32 v14, v14
    s_nop 0
    v_add_f32 v14, 1.0, v14
    v_rcp_f32 v14, v14
    s_nop 0
    v_mul_f32 v22, v22, v14
    v_cvt_pk_bf16_f32 v14, v23, v23
    v_lshlrev_b32 v23, 16, v14
    v_add_f32 v23, v23, v13
    v_cvt_pk_bf16_f32 v14, v23, v23
    v_lshlrev_b32 v23, 16, v14
    v_mul_f32 v14, v23, v23
    v_mov_b32 v15, s37
    v_fma_f32 v14, v14, s38, v15
    v_mul_f32 v14, v14, v23
    v_exp_f32 v14, v14
    s_nop 0
    v_add_f32 v14, 1.0, v14
    v_rcp_f32 v14, v14
    s_nop 0
    v_mul_f32 v23, v23, v14
    v_cvt_pk_bf16_f32 v14, v20, v21
    v_cvt_pk_bf16_f32 v15, v22, v23
    buffer_store_dwordx2 v[14:15], v6, s[16:19], s36 offen offset:16
    s_nop 1
    v_cvt_pk_bf16_f32 v14, v24, v24
    v_lshlrev_b32 v24, 16, v14
    v_add_f32 v24, v24, v13
    v_cvt_pk_bf16_f32 v14, v24, v24
    v_lshlrev_b32 v24, 16, v14
    v_mul_f32 v14, v24, v24
    v_mov_b32 v15, s37
    v_fma_f32 v14, v14, s38, v15
    v_mul_f32 v14, v14, v24
    v_exp_f32 v14, v14
    s_nop 0
    v_add_f32 v14, 1.0, v14
    v_rcp_f32 v14, v14
    s_nop 0
    v_mul_f32 v24, v24, v14
    v_cvt_pk_bf16_f32 v14, v25, v25
    v_lshlrev_b32 v25, 16, v14
    v_add_f32 v25, v25, v13
    v_cvt_pk_bf16_f32 v14, v25, v25
    v_lshlrev_b32 v25, 16, v14
    v_mul_f32 v14, v25, v25
    v_mov_b32 v15, s37
    v_fma_f32 v14, v14, s38, v15
    v_mul_f32 v14, v14, v25
    v_exp_f32 v14, v14
    s_nop 0
    v_add_f32 v14, 1.0, v14
    v_rcp_f32 v14, v14
    s_nop 0
    v_mul_f32 v25, v25, v14
    v_cvt_pk_bf16_f32 v14, v26, v26
    v_lshlrev_b32 v26, 16, v14
    v_add_f32 v26, v26, v13
    v_cvt_pk_bf16_f32 v14, v26, v26
    v_lshlrev_b32 v26, 16, v14
    v_mul_f32 v14, v26, v26
    v_mov_b32 v15, s37
    v_fma_f32 v14, v14, s38, v15
    v_mul_f32 v14, v14, v26
    v_exp_f32 v14, v14
    s_nop 0
    v_add_f32 v14, 1.0, v14
    v_rcp_f32 v14, v14
    s_nop 0
    v_mul_f32 v26, v26, v14
    v_cvt_pk_bf16_f32 v14, v27, v27
    v_lshlrev_b32 v27, 16, v14
    v_add_f32 v27, v27, v13
    v_cvt_pk_bf16_f32 v14, v27, v27
    v_lshlrev_b32 v27, 16, v14
    v_mul_f32 v14, v27, v27
    v_mov_b32 v15, s37
    v_fma_f32 v14, v14, s38, v15
    v_mul_f32 v14, v14, v27
    v_exp_f32 v14, v14
    s_nop 0
    v_add_f32 v14, 1.0, v14
    v_rcp_f32 v14, v14
    s_nop 0
    v_mul_f32 v27, v27, v14
    v_cvt_pk_bf16_f32 v14, v24, v25
    v_cvt_pk_bf16_f32 v15, v26, v27
    buffer_store_dwordx2 v[14:15], v6, s[16:19], s36 offen offset:32
    s_nop 1
    v_cvt_pk_bf16_f32 v14, v28, v28
    v_lshlrev_b32 v28, 16, v14
    v_add_f32 v28, v28, v13
    v_cvt_pk_bf16_f32 v14, v28, v28
    v_lshlrev_b32 v28, 16, v14
    v_mul_f32 v14, v28, v28
    v_mov_b32 v15, s37
    v_fma_f32 v14, v14, s38, v15
    v_mul_f32 v14, v14, v28
    v_exp_f32 v14, v14
    s_nop 0
    v_add_f32 v14, 1.0, v14
    v_rcp_f32 v14, v14
    s_nop 0
    v_mul_f32 v28, v28, v14
    v_cvt_pk_bf16_f32 v14, v29, v29
    v_lshlrev_b32 v29, 16, v14
    v_add_f32 v29, v29, v13
    v_cvt_pk_bf16_f32 v14, v29, v29
    v_lshlrev_b32 v29, 16, v14
    v_mul_f32 v14, v29, v29
    v_mov_b32 v15, s37
    v_fma_f32 v14, v14, s38, v15
    v_mul_f32 v14, v14, v29
    v_exp_f32 v14, v14
    s_nop 0
    v_add_f32 v14, 1.0, v14
    v_rcp_f32 v14, v14
    s_nop 0
    v_mul_f32 v29, v29, v14
    v_cvt_pk_bf16_f32 v14, v30, v30
    v_lshlrev_b32 v30, 16, v14
    v_add_f32 v30, v30, v13
    v_cvt_pk_bf16_f32 v14, v30, v30
    v_lshlrev_b32 v30, 16, v14
    v_mul_f32 v14, v30, v30
    v_mov_b32 v15, s37
    v_fma_f32 v14, v14, s38, v15
    v_mul_f32 v14, v14, v30
    v_exp_f32 v14, v14
    s_nop 0
    v_add_f32 v14, 1.0, v14
    v_rcp_f32 v14, v14
    s_nop 0
    v_mul_f32 v30, v30, v14
    v_cvt_pk_bf16_f32 v14, v31, v31
    v_lshlrev_b32 v31, 16, v14
    v_add_f32 v31, v31, v13
    v_cvt_pk_bf16_f32 v14, v31, v31
    v_lshlrev_b32 v31, 16, v14
    v_mul_f32 v14, v31, v31
    v_mov_b32 v15, s37
    v_fma_f32 v14, v14, s38, v15
    v_mul_f32 v14, v14, v31
    v_exp_f32 v14, v14
    s_nop 0
    v_add_f32 v14, 1.0, v14
    v_rcp_f32 v14, v14
    s_nop 0
    v_mul_f32 v31, v31, v14
    v_cvt_pk_bf16_f32 v14, v28, v29
    v_cvt_pk_bf16_f32 v15, v30, v31
    buffer_store_dwordx2 v[14:15], v6, s[16:19], s36 offen offset:48
    s_nop 1
L_k4_end:
    s_endpgm
.globl k5_gemm2_kernel
.p2align 8
.type k5_gemm2_kernel,@function
k5_gemm2_kernel:
    s_cmp_ge_u32 s2, 320
    s_cbranch_scc1 L_k5_end
    s_load_dwordx2 s[4:5], s[0:1], 112
    s_load_dwordx2 s[6:7], s[0:1], 80
    s_load_dwordx2 s[24:25], s[0:1], 88
    s_load_dwordx2 s[40:41], s[0:1], 96
    s_and_b32 s26, s2, 7
    s_lshr_b32 s27, s2, 3
    s_lshr_b32 s28, s27, 2
    s_and_b32 s29, s27, 3
    s_lshl_b32 s30, s26, 2
    s_add_u32 s29, s29, s30
    s_lshl_b32 s32, s28, 7
    s_lshl_b32 s33, s29, 7
    s_waitcnt lgkmcnt(0)
    s_add_u32 s8, s4, 10485760
    s_addc_u32 s9, s5, 0
    s_mov_b32 s10, 1966080
    s_mov_b32 s11, 0x00020000
    s_mov_b32 s12, s6
    s_mov_b32 s13, s7
    s_mov_b32 s14, 6291456
    s_mov_b32 s15, 0x00020000
    s_add_u32 s16, s4, 5242880
    s_addc_u32 s17, s5, 0
    s_mov_b32 s18, 2621440
    s_mov_b32 s19, 0x00020000
    s_mov_b32 s20, s24
    s_mov_b32 s21, s25
    s_mov_b32 s22, 4096
    s_mov_b32 s23, 0x00020000
    s_mov_b32 s44, s40
    s_mov_b32 s45, s41
    s_mov_b32 s46, 2621440
    s_mov_b32 s47, 0x00020000
    s_mov_b32 s34, s32
    s_mov_b32 s35, s33
    v_lshrrev_b32 v3, 3, v0
    v_and_b32 v4, 7, v0
    v_lshlrev_b32 v5, 4, v4
    v_mul_u32_u24 v6, 1280, v3
    v_add_u32 v6, v6, v5
    v_add_u32 v7, 40960, v6
    v_mul_u32_u24 v8, 4096, v3
    v_add_u32 v8, v8, v5
    v_add_u32 v9, 131072, v8
    v_mul_u32_u24 v10, 320, v3
    v_add_u32 v10, v10, v5
    v_and_b32 v1, 63, v0
    v_lshrrev_b32 v2, 6, v0
    v_lshrrev_b32 v3, 5, v1
    v_lshlrev_b32 v3, 3, v3
    v_and_b32 v4, 15, v1
    v_lshrrev_b32 v4, 2, v4
    v_add_u32 v3, v3, v4
    v_mul_u32_u24 v3, 320, v3
    v_lshrrev_b32 v4, 4, v1
    v_and_b32 v4, 1, v4
    v_lshlrev_b32 v4, 5, v4
    v_and_b32 v5, 3, v1
    v_lshlrev_b32 v5, 3, v5
    v_add_u32 v4, v4, v5
    v_add_u32 v3, v3, v4
    v_and_b32 v4, 1, v2
    v_lshlrev_b32 v4, 6, v4
    v_add_u32 v11, v3, v4
    v_lshrrev_b32 v4, 1, v2
    v_lshlrev_b32 v4, 6, v4
    v_add_u32 v12, v3, v4
    v_add_u32 v12, 128, v12
    v_mov_b32 v16, 0
    v_mov_b32 v17, 0
    v_mov_b32 v18, 0
    v_mov_b32 v19, 0
    v_mov_b32 v20, 0
    v_mov_b32 v21, 0
    v_mov_b32 v22, 0
    v_mov_b32 v23, 0
    v_mov_b32 v24, 0
    v_mov_b32 v25, 0
    v_mov_b32 v26, 0
    v_mov_b32 v27, 0
    v_mov_b32 v28, 0
    v_mov_b32 v29, 0
    v_mov_b32 v30, 0
    v_mov_b32 v31, 0
    buffer_load_dwordx4 v[64:67], v6, s[8:11], s34 offen
    buffer_load_dwordx4 v[68:71], v7, s[8:11], s34 offen
    buffer_load_dwordx4 v[72:75], v8, s[12:15], s35 offen
    buffer_load_dwordx4 v[76:79], v9, s[12:15], s35 offen
    s_add_u32 s34, s34, 81920
    s_add_u32 s35, s35, 262144
    buffer_load_dwordx4 v[80:83], v6, s[8:11], s34 offen
    buffer_load_dwordx4 v[84:87], v7, s[8:11], s34 offen
    buffer_load_dwordx4 v[88:91], v8, s[12:15], s35 offen
    buffer_load_dwordx4 v[92:95], v9, s[12:15], s35 offen
    s_add_u32 s34, s34, 81920
    s_add_u32 s35, s35, 262144
    buffer_load_dwordx4 v[96:99], v6, s[8:11], s34 offen
    buffer_load_dwordx4 v[100:103], v7, s[8:11], s34 offen
    buffer_load_dwordx4 v[104:107], v8, s[12:15], s35 offen
    buffer_load_dwordx4 v[108:111], v9, s[12:15], s35 offen
    s_add_u32 s34, s34, 81920
    s_add_u32 s35, s35, 262144
    buffer_load_dwordx4 v[112:115], v6, s[8:11], s34 offen
    buffer_load_dwordx4 v[116:119], v7, s[8:11], s34 offen
    buffer_load_dwordx4 v[120:123], v8, s[12:15], s35 offen
    buffer_load_dwordx4 v[124:127], v9, s[12:15], s35 offen
    s_add_u32 s34, s34, 81920
    s_add_u32 s35, s35, 262144
    buffer_load_dwordx4 v[128:131], v6, s[8:11], s34 offen
    buffer_load_dwordx4 v[132:135], v7, s[8:11], s34 offen
    buffer_load_dwordx4 v[136:139], v8, s[12:15], s35 offen
    buffer_load_dwordx4 v[140:143], v9, s[12:15], s35 offen
    s_add_u32 s34, s34, 81920
    s_add_u32 s35, s35, 262144
    buffer_load_dwordx4 v[144:147], v6, s[8:11], s34 offen
    buffer_load_dwordx4 v[148:151], v7, s[8:11], s34 offen
    buffer_load_dwordx4 v[152:155], v8, s[12:15], s35 offen
    buffer_load_dwordx4 v[156:159], v9, s[12:15], s35 offen
    s_add_u32 s34, s34, 81920
    s_add_u32 s35, s35, 262144
    buffer_load_dwordx4 v[160:163], v6, s[8:11], s34 offen
    buffer_load_dwordx4 v[164:167], v7, s[8:11], s34 offen
    buffer_load_dwordx4 v[168:171], v8, s[12:15], s35 offen
    buffer_load_dwordx4 v[172:175], v9, s[12:15], s35 offen
    s_add_u32 s34, s34, 81920
    s_add_u32 s35, s35, 262144
    buffer_load_dwordx4 v[176:179], v6, s[8:11], s34 offen
    buffer_load_dwordx4 v[180:183], v7, s[8:11], s34 offen
    buffer_load_dwordx4 v[184:187], v8, s[12:15], s35 offen
    buffer_load_dwordx4 v[188:191], v9, s[12:15], s35 offen
    s_add_u32 s34, s34, 81920
    s_add_u32 s35, s35, 262144
    s_waitcnt vmcnt(28)
    ds_write_b128 v10, v[64:67] offset:0
    ds_write_b128 v10, v[68:71] offset:10240
    ds_write_b128 v10, v[72:75] offset:128
    ds_write_b128 v10, v[76:79] offset:10368
    s_waitcnt lgkmcnt(0)
    buffer_load_dwordx4 v[64:67], v6, s[8:11], s34 offen
    buffer_load_dwordx4 v[68:71], v7, s[8:11], s34 offen
    buffer_load_dwordx4 v[72:75], v8, s[12:15], s35 offen
    buffer_load_dwordx4 v[76:79], v9, s[12:15], s35 offen
    s_add_u32 s34, s34, 81920
    s_add_u32 s35, s35, 262144
    s_barrier
    ds_read_b64_tr_b16 v[32:33], v11 offset:0
    ds_read_b64_tr_b16 v[34:35], v11 offset:1280
    ds_read_b64_tr_b16 v[48:49], v12 offset:0
    ds_read_b64_tr_b16 v[50:51], v12 offset:1280
    ds_read_b64_tr_b16 v[36:37], v11 offset:5120
    ds_read_b64_tr_b16 v[38:39], v11 offset:6400
    ds_read_b64_tr_b16 v[52:53], v12 offset:5120
    ds_read_b64_tr_b16 v[54:55], v12 offset:6400
    ds_read_b64_tr_b16 v[40:41], v11 offset:10240
    ds_read_b64_tr_b16 v[42:43], v11 offset:11520
    ds_read_b64_tr_b16 v[56:57], v12 offset:10240
    ds_read_b64_tr_b16 v[58:59], v12 offset:11520
    ds_read_b64_tr_b16 v[44:45], v11 offset:15360
    ds_read_b64_tr_b16 v[46:47], v11 offset:16640
    ds_read_b64_tr_b16 v[60:61], v12 offset:15360
    ds_read_b64_tr_b16 v[62:63], v12 offset:16640
    s_waitcnt lgkmcnt(12)
    v_mfma_f32_32x32x16_bf16 v[16:31], v[32:35], v[48:51], v[16:31]
    s_waitcnt lgkmcnt(8)
    v_mfma_f32_32x32x16_bf16 v[16:31], v[36:39], v[52:55], v[16:31]
    s_waitcnt lgkmcnt(4)
    v_mfma_f32_32x32x16_bf16 v[16:31], v[40:43], v[56:59], v[16:31]
    s_waitcnt lgkmcnt(0)
    v_mfma_f32_32x32x16_bf16 v[16:31], v[44:47], v[60:63], v[16:31]
    s_waitcnt vmcnt(28)
    ds_write_b128 v10, v[80:83] offset:20480
    ds_write_b128 v10, v[84:87] offset:30720
    ds_write_b128 v10, v[88:91] offset:20608
    ds_write_b128 v10, v[92:95] offset:30848
    s_waitcnt lgkmcnt(0)
    buffer_load_dwordx4 v[80:83], v6, s[8:11], s34 offen
    buffer_load_dwordx4 v[84:87], v7, s[8:11], s34 offen
    buffer_load_dwordx4 v[88:91], v8, s[12:15], s35 offen
    buffer_load_dwordx4 v[92:95], v9, s[12:15], s35 offen
    s_add_u32 s34, s34, 81920
    s_add_u32 s35, s35, 262144
    s_barrier
    ds_read_b64_tr_b16 v[32:33], v11 offset:20480
    ds_read_b64_tr_b16 v[34:35], v11 offset:21760
    ds_read_b64_tr_b16 v[48:49], v12 offset:20480
    ds_read_b64_tr_b16 v[50:51], v12 offset:21760
    ds_read_b64_tr_b16 v[36:37], v11 offset:25600
    ds_read_b64_tr_b16 v[38:39], v11 offset:26880
    ds_read_b64_tr_b16 v[52:53], v12 offset:25600
    ds_read_b64_tr_b16 v[54:55], v12 offset:26880
    ds_read_b64_tr_b16 v[40:41], v11 offset:30720
    ds_read_b64_tr_b16 v[42:43], v11 offset:32000
    ds_read_b64_tr_b16 v[56:57], v12 offset:30720
    ds_read_b64_tr_b16 v[58:59], v12 offset:32000
    ds_read_b64_tr_b16 v[44:45], v11 offset:35840
    ds_read_b64_tr_b16 v[46:47], v11 offset:37120
    ds_read_b64_tr_b16 v[60:61], v12 offset:35840
    ds_read_b64_tr_b16 v[62:63], v12 offset:37120
    s_waitcnt lgkmcnt(12)
    v_mfma_f32_32x32x16_bf16 v[16:31], v[32:35], v[48:51], v[16:31]
    s_waitcnt lgkmcnt(8)
    v_mfma_f32_32x32x16_bf16 v[16:31], v[36:39], v[52:55], v[16:31]
    s_waitcnt lgkmcnt(4)
    v_mfma_f32_32x32x16_bf16 v[16:31], v[40:43], v[56:59], v[16:31]
    s_waitcnt lgkmcnt(0)
    v_mfma_f32_32x32x16_bf16 v[16:31], v[44:47], v[60:63], v[16:31]
    s_waitcnt vmcnt(28)
    ds_write_b128 v10, v[96:99] offset:0
    ds_write_b128 v10, v[100:103] offset:10240
    ds_write_b128 v10, v[104:107] offset:128
    ds_write_b128 v10, v[108:111] offset:10368
    s_waitcnt lgkmcnt(0)
    buffer_load_dwordx4 v[96:99], v6, s[8:11], s34 offen
    buffer_load_dwordx4 v[100:103], v7, s[8:11], s34 offen
    buffer_load_dwordx4 v[104:107], v8, s[12:15], s35 offen
    buffer_load_dwordx4 v[108:111], v9, s[12:15], s35 offen
    s_add_u32 s34, s34, 81920
    s_add_u32 s35, s35, 262144
    s_barrier
    ds_read_b64_tr_b16 v[32:33], v11 offset:0
    ds_read_b64_tr_b16 v[34:35], v11 offset:1280
    ds_read_b64_tr_b16 v[48:49], v12 offset:0
    ds_read_b64_tr_b16 v[50:51], v12 offset:1280
    ds_read_b64_tr_b16 v[36:37], v11 offset:5120
    ds_read_b64_tr_b16 v[38:39], v11 offset:6400
    ds_read_b64_tr_b16 v[52:53], v12 offset:5120
    ds_read_b64_tr_b16 v[54:55], v12 offset:6400
    ds_read_b64_tr_b16 v[40:41], v11 offset:10240
    ds_read_b64_tr_b16 v[42:43], v11 offset:11520
    ds_read_b64_tr_b16 v[56:57], v12 offset:10240
    ds_read_b64_tr_b16 v[58:59], v12 offset:11520
    ds_read_b64_tr_b16 v[44:45], v11 offset:15360
    ds_read_b64_tr_b16 v[46:47], v11 offset:16640
    ds_read_b64_tr_b16 v[60:61], v12 offset:15360
    ds_read_b64_tr_b16 v[62:63], v12 offset:16640
    s_waitcnt lgkmcnt(12)
    v_mfma_f32_32x32x16_bf16 v[16:31], v[32:35], v[48:51], v[16:31]
    s_waitcnt lgkmcnt(8)
    v_mfma_f32_32x32x16_bf16 v[16:31], v[36:39], v[52:55], v[16:31]
    s_waitcnt lgkmcnt(4)
    v_mfma_f32_32x32x16_bf16 v[16:31], v[40:43], v[56:59], v[16:31]
    s_waitcnt lgkmcnt(0)
    v_mfma_f32_32x32x16_bf16 v[16:31], v[44:47], v[60:63], v[16:31]
    s_waitcnt vmcnt(28)
    ds_write_b128 v10, v[112:115] offset:20480
    ds_write_b128 v10, v[116:119] offset:30720
    ds_write_b128 v10, v[120:123] offset:20608
    ds_write_b128 v10, v[124:127] offset:30848
    s_waitcnt lgkmcnt(0)
    buffer_load_dwordx4 v[112:115], v6, s[8:11], s34 offen
    buffer_load_dwordx4 v[116:119], v7, s[8:11], s34 offen
    buffer_load_dwordx4 v[120:123], v8, s[12:15], s35 offen
    buffer_load_dwordx4 v[124:127], v9, s[12:15], s35 offen
    s_add_u32 s34, s34, 81920
    s_add_u32 s35, s35, 262144
    s_barrier
    ds_read_b64_tr_b16 v[32:33], v11 offset:20480
    ds_read_b64_tr_b16 v[34:35], v11 offset:21760
    ds_read_b64_tr_b16 v[48:49], v12 offset:20480
    ds_read_b64_tr_b16 v[50:51], v12 offset:21760
    ds_read_b64_tr_b16 v[36:37], v11 offset:25600
    ds_read_b64_tr_b16 v[38:39], v11 offset:26880
    ds_read_b64_tr_b16 v[52:53], v12 offset:25600
    ds_read_b64_tr_b16 v[54:55], v12 offset:26880
    ds_read_b64_tr_b16 v[40:41], v11 offset:30720
    ds_read_b64_tr_b16 v[42:43], v11 offset:32000
    ds_read_b64_tr_b16 v[56:57], v12 offset:30720
    ds_read_b64_tr_b16 v[58:59], v12 offset:32000
    ds_read_b64_tr_b16 v[44:45], v11 offset:35840
    ds_read_b64_tr_b16 v[46:47], v11 offset:37120
    ds_read_b64_tr_b16 v[60:61], v12 offset:35840
    ds_read_b64_tr_b16 v[62:63], v12 offset:37120
    s_waitcnt lgkmcnt(12)
    v_mfma_f32_32x32x16_bf16 v[16:31], v[32:35], v[48:51], v[16:31]
    s_waitcnt lgkmcnt(8)
    v_mfma_f32_32x32x16_bf16 v[16:31], v[36:39], v[52:55], v[16:31]
    s_waitcnt lgkmcnt(4)
    v_mfma_f32_32x32x16_bf16 v[16:31], v[40:43], v[56:59], v[16:31]
    s_waitcnt lgkmcnt(0)
    v_mfma_f32_32x32x16_bf16 v[16:31], v[44:47], v[60:63], v[16:31]
    s_waitcnt vmcnt(28)
    ds_write_b128 v10, v[128:131] offset:0
    ds_write_b128 v10, v[132:135] offset:10240
    ds_write_b128 v10, v[136:139] offset:128
    ds_write_b128 v10, v[140:143] offset:10368
    s_waitcnt lgkmcnt(0)
    buffer_load_dwordx4 v[128:131], v6, s[8:11], s34 offen
    buffer_load_dwordx4 v[132:135], v7, s[8:11], s34 offen
    buffer_load_dwordx4 v[136:139], v8, s[12:15], s35 offen
    buffer_load_dwordx4 v[140:143], v9, s[12:15], s35 offen
    s_add_u32 s34, s34, 81920
    s_add_u32 s35, s35, 262144
    s_barrier
    ds_read_b64_tr_b16 v[32:33], v11 offset:0
    ds_read_b64_tr_b16 v[34:35], v11 offset:1280
    ds_read_b64_tr_b16 v[48:49], v12 offset:0
    ds_read_b64_tr_b16 v[50:51], v12 offset:1280
    ds_read_b64_tr_b16 v[36:37], v11 offset:5120
    ds_read_b64_tr_b16 v[38:39], v11 offset:6400
    ds_read_b64_tr_b16 v[52:53], v12 offset:5120
    ds_read_b64_tr_b16 v[54:55], v12 offset:6400
    ds_read_b64_tr_b16 v[40:41], v11 offset:10240
    ds_read_b64_tr_b16 v[42:43], v11 offset:11520
    ds_read_b64_tr_b16 v[56:57], v12 offset:10240
    ds_read_b64_tr_b16 v[58:59], v12 offset:11520
    ds_read_b64_tr_b16 v[44:45], v11 offset:15360
    ds_read_b64_tr_b16 v[46:47], v11 offset:16640
    ds_read_b64_tr_b16 v[60:61], v12 offset:15360
    ds_read_b64_tr_b16 v[62:63], v12 offset:16640
    s_waitcnt lgkmcnt(12)
    v_mfma_f32_32x32x16_bf16 v[16:31], v[32:35], v[48:51], v[16:31]
    s_waitcnt lgkmcnt(8)
    v_mfma_f32_32x32x16_bf16 v[16:31], v[36:39], v[52:55], v[16:31]
    s_waitcnt lgkmcnt(4)
    v_mfma_f32_32x32x16_bf16 v[16:31], v[40:43], v[56:59], v[16:31]
    s_waitcnt lgkmcnt(0)
    v_mfma_f32_32x32x16_bf16 v[16:31], v[44:47], v[60:63], v[16:31]
    s_waitcnt vmcnt(28)
    ds_write_b128 v10, v[144:147] offset:20480
    ds_write_b128 v10, v[148:151] offset:30720
    ds_write_b128 v10, v[152:155] offset:20608
    ds_write_b128 v10, v[156:159] offset:30848
    s_waitcnt lgkmcnt(0)
    buffer_load_dwordx4 v[144:147], v6, s[8:11], s34 offen
    buffer_load_dwordx4 v[148:151], v7, s[8:11], s34 offen
    buffer_load_dwordx4 v[152:155], v8, s[12:15], s35 offen
    buffer_load_dwordx4 v[156:159], v9, s[12:15], s35 offen
    s_add_u32 s34, s34, 81920
    s_add_u32 s35, s35, 262144
    s_barrier
    ds_read_b64_tr_b16 v[32:33], v11 offset:20480
    ds_read_b64_tr_b16 v[34:35], v11 offset:21760
    ds_read_b64_tr_b16 v[48:49], v12 offset:20480
    ds_read_b64_tr_b16 v[50:51], v12 offset:21760
    ds_read_b64_tr_b16 v[36:37], v11 offset:25600
    ds_read_b64_tr_b16 v[38:39], v11 offset:26880
    ds_read_b64_tr_b16 v[52:53], v12 offset:25600
    ds_read_b64_tr_b16 v[54:55], v12 offset:26880
    ds_read_b64_tr_b16 v[40:41], v11 offset:30720
    ds_read_b64_tr_b16 v[42:43], v11 offset:32000
    ds_read_b64_tr_b16 v[56:57], v12 offset:30720
    ds_read_b64_tr_b16 v[58:59], v12 offset:32000
    ds_read_b64_tr_b16 v[44:45], v11 offset:35840
    ds_read_b64_tr_b16 v[46:47], v11 offset:37120
    ds_read_b64_tr_b16 v[60:61], v12 offset:35840
    ds_read_b64_tr_b16 v[62:63], v12 offset:37120
    s_waitcnt lgkmcnt(12)
    v_mfma_f32_32x32x16_bf16 v[16:31], v[32:35], v[48:51], v[16:31]
    s_waitcnt lgkmcnt(8)
    v_mfma_f32_32x32x16_bf16 v[16:31], v[36:39], v[52:55], v[16:31]
    s_waitcnt lgkmcnt(4)
    v_mfma_f32_32x32x16_bf16 v[16:31], v[40:43], v[56:59], v[16:31]
    s_waitcnt lgkmcnt(0)
    v_mfma_f32_32x32x16_bf16 v[16:31], v[44:47], v[60:63], v[16:31]
    s_waitcnt vmcnt(28)
    ds_write_b128 v10, v[160:163] offset:0
    ds_write_b128 v10, v[164:167] offset:10240
    ds_write_b128 v10, v[168:171] offset:128
    ds_write_b128 v10, v[172:175] offset:10368
    s_waitcnt lgkmcnt(0)
    buffer_load_dwordx4 v[160:163], v6, s[8:11], s34 offen
    buffer_load_dwordx4 v[164:167], v7, s[8:11], s34 offen
    buffer_load_dwordx4 v[168:171], v8, s[12:15], s35 offen
    buffer_load_dwordx4 v[172:175], v9, s[12:15], s35 offen
    s_add_u32 s34, s34, 81920
    s_add_u32 s35, s35, 262144
    s_barrier
    ds_read_b64_tr_b16 v[32:33], v11 offset:0
    ds_read_b64_tr_b16 v[34:35], v11 offset:1280
    ds_read_b64_tr_b16 v[48:49], v12 offset:0
    ds_read_b64_tr_b16 v[50:51], v12 offset:1280
    ds_read_b64_tr_b16 v[36:37], v11 offset:5120
    ds_read_b64_tr_b16 v[38:39], v11 offset:6400
    ds_read_b64_tr_b16 v[52:53], v12 offset:5120
    ds_read_b64_tr_b16 v[54:55], v12 offset:6400
    ds_read_b64_tr_b16 v[40:41], v11 offset:10240
    ds_read_b64_tr_b16 v[42:43], v11 offset:11520
    ds_read_b64_tr_b16 v[56:57], v12 offset:10240
    ds_read_b64_tr_b16 v[58:59], v12 offset:11520
    ds_read_b64_tr_b16 v[44:45], v11 offset:15360
    ds_read_b64_tr_b16 v[46:47], v11 offset:16640
    ds_read_b64_tr_b16 v[60:61], v12 offset:15360
    ds_read_b64_tr_b16 v[62:63], v12 offset:16640
    s_waitcnt lgkmcnt(12)
    v_mfma_f32_32x32x16_bf16 v[16:31], v[32:35], v[48:51], v[16:31]
    s_waitcnt lgkmcnt(8)
    v_mfma_f32_32x32x16_bf16 v[16:31], v[36:39], v[52:55], v[16:31]
    s_waitcnt lgkmcnt(4)
    v_mfma_f32_32x32x16_bf16 v[16:31], v[40:43], v[56:59], v[16:31]
    s_waitcnt lgkmcnt(0)
    v_mfma_f32_32x32x16_bf16 v[16:31], v[44:47], v[60:63], v[16:31]
    s_waitcnt vmcnt(28)
    ds_write_b128 v10, v[176:179] offset:20480
    ds_write_b128 v10, v[180:183] offset:30720
    ds_write_b128 v10, v[184:187] offset:20608
    ds_write_b128 v10, v[188:191] offset:30848
    s_waitcnt lgkmcnt(0)
    buffer_load_dwordx4 v[176:179], v6, s[8:11], s34 offen
    buffer_load_dwordx4 v[180:183], v7, s[8:11], s34 offen
    buffer_load_dwordx4 v[184:187], v8, s[12:15], s35 offen
    buffer_load_dwordx4 v[188:191], v9, s[12:15], s35 offen
    s_add_u32 s34, s34, 81920
    s_add_u32 s35, s35, 262144
    s_barrier
    ds_read_b64_tr_b16 v[32:33], v11 offset:20480
    ds_read_b64_tr_b16 v[34:35], v11 offset:21760
    ds_read_b64_tr_b16 v[48:49], v12 offset:20480
    ds_read_b64_tr_b16 v[50:51], v12 offset:21760
    ds_read_b64_tr_b16 v[36:37], v11 offset:25600
    ds_read_b64_tr_b16 v[38:39], v11 offset:26880
    ds_read_b64_tr_b16 v[52:53], v12 offset:25600
    ds_read_b64_tr_b16 v[54:55], v12 offset:26880
    ds_read_b64_tr_b16 v[40:41], v11 offset:30720
    ds_read_b64_tr_b16 v[42:43], v11 offset:32000
    ds_read_b64_tr_b16 v[56:57], v12 offset:30720
    ds_read_b64_tr_b16 v[58:59], v12 offset:32000
    ds_read_b64_tr_b16 v[44:45], v11 offset:35840
    ds_read_b64_tr_b16 v[46:47], v11 offset:37120
    ds_read_b64_tr_b16 v[60:61], v12 offset:35840
    ds_read_b64_tr_b16 v[62:63], v12 offset:37120
    s_waitcnt lgkmcnt(12)
    v_mfma_f32_32x32x16_bf16 v[16:31], v[32:35], v[48:51], v[16:31]
    s_waitcnt lgkmcnt(8)
    v_mfma_f32_32x32x16_bf16 v[16:31], v[36:39], v[52:55], v[16:31]
    s_waitcnt lgkmcnt(4)
    v_mfma_f32_32x32x16_bf16 v[16:31], v[40:43], v[56:59], v[16:31]
    s_waitcnt lgkmcnt(0)
    v_mfma_f32_32x32x16_bf16 v[16:31], v[44:47], v[60:63], v[16:31]
    s_waitcnt vmcnt(28)
    ds_write_b128 v10, v[64:67] offset:0
    ds_write_b128 v10, v[68:71] offset:10240
    ds_write_b128 v10, v[72:75] offset:128
    ds_write_b128 v10, v[76:79] offset:10368
    s_waitcnt lgkmcnt(0)
    buffer_load_dwordx4 v[64:67], v6, s[8:11], s34 offen
    buffer_load_dwordx4 v[68:71], v7, s[8:11], s34 offen
    buffer_load_dwordx4 v[72:75], v8, s[12:15], s35 offen
    buffer_load_dwordx4 v[76:79], v9, s[12:15], s35 offen
    s_add_u32 s34, s34, 81920
    s_add_u32 s35, s35, 262144
    s_barrier
    ds_read_b64_tr_b16 v[32:33], v11 offset:0
    ds_read_b64_tr_b16 v[34:35], v11 offset:1280
    ds_read_b64_tr_b16 v[48:49], v12 offset:0
    ds_read_b64_tr_b16 v[50:51], v12 offset:1280
    ds_read_b64_tr_b16 v[36:37], v11 offset:5120
    ds_read_b64_tr_b16 v[38:39], v11 offset:6400
    ds_read_b64_tr_b16 v[52:53], v12 offset:5120
    ds_read_b64_tr_b16 v[54:55], v12 offset:6400
    ds_read_b64_tr_b16 v[40:41], v11 offset:10240
    ds_read_b64_tr_b16 v[42:43], v11 offset:11520
    ds_read_b64_tr_b16 v[56:57], v12 offset:10240
    ds_read_b64_tr_b16 v[58:59], v12 offset:11520
    ds_read_b64_tr_b16 v[44:45], v11 offset:15360
    ds_read_b64_tr_b16 v[46:47], v11 offset:16640
    ds_read_b64_tr_b16 v[60:61], v12 offset:15360
    ds_read_b64_tr_b16 v[62:63], v12 offset:16640
    s_waitcnt lgkmcnt(12)
    v_mfma_f32_32x32x16_bf16 v[16:31], v[32:35], v[48:51], v[16:31]
    s_waitcnt lgkmcnt(8)
    v_mfma_f32_32x32x16_bf16 v[16:31], v[36:39], v[52:55], v[16:31]
    s_waitcnt lgkmcnt(4)
    v_mfma_f32_32x32x16_bf16 v[16:31], v[40:43], v[56:59], v[16:31]
    s_waitcnt lgkmcnt(0)
    v_mfma_f32_32x32x16_bf16 v[16:31], v[44:47], v[60:63], v[16:31]
    s_waitcnt vmcnt(28)
    ds_write_b128 v10, v[80:83] offset:20480
    ds_write_b128 v10, v[84:87] offset:30720
    ds_write_b128 v10, v[88:91] offset:20608
    ds_write_b128 v10, v[92:95] offset:30848
    s_waitcnt lgkmcnt(0)
    buffer_load_dwordx4 v[80:83], v6, s[8:11], s34 offen
    buffer_load_dwordx4 v[84:87], v7, s[8:11], s34 offen
    buffer_load_dwordx4 v[88:91], v8, s[12:15], s35 offen
    buffer_load_dwordx4 v[92:95], v9, s[12:15], s35 offen
    s_add_u32 s34, s34, 81920
    s_add_u32 s35, s35, 262144
    s_barrier
    ds_read_b64_tr_b16 v[32:33], v11 offset:20480
    ds_read_b64_tr_b16 v[34:35], v11 offset:21760
    ds_read_b64_tr_b16 v[48:49], v12 offset:20480
    ds_read_b64_tr_b16 v[50:51], v12 offset:21760
    ds_read_b64_tr_b16 v[36:37], v11 offset:25600
    ds_read_b64_tr_b16 v[38:39], v11 offset:26880
    ds_read_b64_tr_b16 v[52:53], v12 offset:25600
    ds_read_b64_tr_b16 v[54:55], v12 offset:26880
    ds_read_b64_tr_b16 v[40:41], v11 offset:30720
    ds_read_b64_tr_b16 v[42:43], v11 offset:32000
    ds_read_b64_tr_b16 v[56:57], v12 offset:30720
    ds_read_b64_tr_b16 v[58:59], v12 offset:32000
    ds_read_b64_tr_b16 v[44:45], v11 offset:35840
    ds_read_b64_tr_b16 v[46:47], v11 offset:37120
    ds_read_b64_tr_b16 v[60:61], v12 offset:35840
    ds_read_b64_tr_b16 v[62:63], v12 offset:37120
    s_waitcnt lgkmcnt(12)
    v_mfma_f32_32x32x16_bf16 v[16:31], v[32:35], v[48:51], v[16:31]
    s_waitcnt lgkmcnt(8)
    v_mfma_f32_32x32x16_bf16 v[16:31], v[36:39], v[52:55], v[16:31]
    s_waitcnt lgkmcnt(4)
    v_mfma_f32_32x32x16_bf16 v[16:31], v[40:43], v[56:59], v[16:31]
    s_waitcnt lgkmcnt(0)
    v_mfma_f32_32x32x16_bf16 v[16:31], v[44:47], v[60:63], v[16:31]
    s_waitcnt vmcnt(28)
    ds_write_b128 v10, v[96:99] offset:0
    ds_write_b128 v10, v[100:103] offset:10240
    ds_write_b128 v10, v[104:107] offset:128
    ds_write_b128 v10, v[108:111] offset:10368
    s_waitcnt lgkmcnt(0)
    buffer_load_dwordx4 v[96:99], v6, s[8:11], s34 offen
    buffer_load_dwordx4 v[100:103], v7, s[8:11], s34 offen
    buffer_load_dwordx4 v[104:107], v8, s[12:15], s35 offen
    buffer_load_dwordx4 v[108:111], v9, s[12:15], s35 offen
    s_add_u32 s34, s34, 81920
    s_add_u32 s35, s35, 262144
    s_barrier
    ds_read_b64_tr_b16 v[32:33], v11 offset:0
    ds_read_b64_tr_b16 v[34:35], v11 offset:1280
    ds_read_b64_tr_b16 v[48:49], v12 offset:0
    ds_read_b64_tr_b16 v[50:51], v12 offset:1280
    ds_read_b64_tr_b16 v[36:37], v11 offset:5120
    ds_read_b64_tr_b16 v[38:39], v11 offset:6400
    ds_read_b64_tr_b16 v[52:53], v12 offset:5120
    ds_read_b64_tr_b16 v[54:55], v12 offset:6400
    ds_read_b64_tr_b16 v[40:41], v11 offset:10240
    ds_read_b64_tr_b16 v[42:43], v11 offset:11520
    ds_read_b64_tr_b16 v[56:57], v12 offset:10240
    ds_read_b64_tr_b16 v[58:59], v12 offset:11520
    ds_read_b64_tr_b16 v[44:45], v11 offset:15360
    ds_read_b64_tr_b16 v[46:47], v11 offset:16640
    ds_read_b64_tr_b16 v[60:61], v12 offset:15360
    ds_read_b64_tr_b16 v[62:63], v12 offset:16640
    s_waitcnt lgkmcnt(12)
    v_mfma_f32_32x32x16_bf16 v[16:31], v[32:35], v[48:51], v[16:31]
    s_waitcnt lgkmcnt(8)
    v_mfma_f32_32x32x16_bf16 v[16:31], v[36:39], v[52:55], v[16:31]
    s_waitcnt lgkmcnt(4)
    v_mfma_f32_32x32x16_bf16 v[16:31], v[40:43], v[56:59], v[16:31]
    s_waitcnt lgkmcnt(0)
    v_mfma_f32_32x32x16_bf16 v[16:31], v[44:47], v[60:63], v[16:31]
    s_waitcnt vmcnt(28)
    ds_write_b128 v10, v[112:115] offset:20480
    ds_write_b128 v10, v[116:119] offset:30720
    ds_write_b128 v10, v[120:123] offset:20608
    ds_write_b128 v10, v[124:127] offset:30848
    s_waitcnt lgkmcnt(0)
    buffer_load_dwordx4 v[112:115], v6, s[8:11], s34 offen
    buffer_load_dwordx4 v[116:119], v7, s[8:11], s34 offen
    buffer_load_dwordx4 v[120:123], v8, s[12:15], s35 offen
    buffer_load_dwordx4 v[124:127], v9, s[12:15], s35 offen
    s_add_u32 s34, s34, 81920
    s_add_u32 s35, s35, 262144
    s_barrier
    ds_read_b64_tr_b16 v[32:33], v11 offset:20480
    ds_read_b64_tr_b16 v[34:35], v11 offset:21760
    ds_read_b64_tr_b16 v[48:49], v12 offset:20480
    ds_read_b64_tr_b16 v[50:51], v12 offset:21760
    ds_read_b64_tr_b16 v[36:37], v11 offset:25600
    ds_read_b64_tr_b16 v[38:39], v11 offset:26880
    ds_read_b64_tr_b16 v[52:53], v12 offset:25600
    ds_read_b64_tr_b16 v[54:55], v12 offset:26880
    ds_read_b64_tr_b16 v[40:41], v11 offset:30720
    ds_read_b64_tr_b16 v[42:43], v11 offset:32000
    ds_read_b64_tr_b16 v[56:57], v12 offset:30720
    ds_read_b64_tr_b16 v[58:59], v12 offset:32000
    ds_read_b64_tr_b16 v[44:45], v11 offset:35840
    ds_read_b64_tr_b16 v[46:47], v11 offset:37120
    ds_read_b64_tr_b16 v[60:61], v12 offset:35840
    ds_read_b64_tr_b16 v[62:63], v12 offset:37120
    s_waitcnt lgkmcnt(12)
    v_mfma_f32_32x32x16_bf16 v[16:31], v[32:35], v[48:51], v[16:31]
    s_waitcnt lgkmcnt(8)
    v_mfma_f32_32x32x16_bf16 v[16:31], v[36:39], v[52:55], v[16:31]
    s_waitcnt lgkmcnt(4)
    v_mfma_f32_32x32x16_bf16 v[16:31], v[40:43], v[56:59], v[16:31]
    s_waitcnt lgkmcnt(0)
    v_mfma_f32_32x32x16_bf16 v[16:31], v[44:47], v[60:63], v[16:31]
    s_waitcnt vmcnt(28)
    ds_write_b128 v10, v[128:131] offset:0
    ds_write_b128 v10, v[132:135] offset:10240
    ds_write_b128 v10, v[136:139] offset:128
    ds_write_b128 v10, v[140:143] offset:10368
    s_waitcnt lgkmcnt(0)
    buffer_load_dwordx4 v[128:131], v6, s[8:11], s34 offen
    buffer_load_dwordx4 v[132:135], v7, s[8:11], s34 offen
    buffer_load_dwordx4 v[136:139], v8, s[12:15], s35 offen
    buffer_load_dwordx4 v[140:143], v9, s[12:15], s35 offen
    s_add_u32 s34, s34, 81920
    s_add_u32 s35, s35, 262144
    s_barrier
    ds_read_b64_tr_b16 v[32:33], v11 offset:0
    ds_read_b64_tr_b16 v[34:35], v11 offset:1280
    ds_read_b64_tr_b16 v[48:49], v12 offset:0
    ds_read_b64_tr_b16 v[50:51], v12 offset:1280
    ds_read_b64_tr_b16 v[36:37], v11 offset:5120
    ds_read_b64_tr_b16 v[38:39], v11 offset:6400
    ds_read_b64_tr_b16 v[52:53], v12 offset:5120
    ds_read_b64_tr_b16 v[54:55], v12 offset:6400
    ds_read_b64_tr_b16 v[40:41], v11 offset:10240
    ds_read_b64_tr_b16 v[42:43], v11 offset:11520
    ds_read_b64_tr_b16 v[56:57], v12 offset:10240
    ds_read_b64_tr_b16 v[58:59], v12 offset:11520
    ds_read_b64_tr_b16 v[44:45], v11 offset:15360
    ds_read_b64_tr_b16 v[46:47], v11 offset:16640
    ds_read_b64_tr_b16 v[60:61], v12 offset:15360
    ds_read_b64_tr_b16 v[62:63], v12 offset:16640
    s_waitcnt lgkmcnt(12)
    v_mfma_f32_32x32x16_bf16 v[16:31], v[32:35], v[48:51], v[16:31]
    s_waitcnt lgkmcnt(8)
    v_mfma_f32_32x32x16_bf16 v[16:31], v[36:39], v[52:55], v[16:31]
    s_waitcnt lgkmcnt(4)
    v_mfma_f32_32x32x16_bf16 v[16:31], v[40:43], v[56:59], v[16:31]
    s_waitcnt lgkmcnt(0)
    v_mfma_f32_32x32x16_bf16 v[16:31], v[44:47], v[60:63], v[16:31]
    s_waitcnt vmcnt(28)
    ds_write_b128 v10, v[144:147] offset:20480
    ds_write_b128 v10, v[148:151] offset:30720
    ds_write_b128 v10, v[152:155] offset:20608
    ds_write_b128 v10, v[156:159] offset:30848
    s_waitcnt lgkmcnt(0)
    buffer_load_dwordx4 v[144:147], v6, s[8:11], s34 offen
    buffer_load_dwordx4 v[148:151], v7, s[8:11], s34 offen
    buffer_load_dwordx4 v[152:155], v8, s[12:15], s35 offen
    buffer_load_dwordx4 v[156:159], v9, s[12:15], s35 offen
    s_add_u32 s34, s34, 81920
    s_add_u32 s35, s35, 262144
    s_barrier
    ds_read_b64_tr_b16 v[32:33], v11 offset:20480
    ds_read_b64_tr_b16 v[34:35], v11 offset:21760
    ds_read_b64_tr_b16 v[48:49], v12 offset:20480
    ds_read_b64_tr_b16 v[50:51], v12 offset:21760
    ds_read_b64_tr_b16 v[36:37], v11 offset:25600
    ds_read_b64_tr_b16 v[38:39], v11 offset:26880
    ds_read_b64_tr_b16 v[52:53], v12 offset:25600
    ds_read_b64_tr_b16 v[54:55], v12 offset:26880
    ds_read_b64_tr_b16 v[40:41], v11 offset:30720
    ds_read_b64_tr_b16 v[42:43], v11 offset:32000
    ds_read_b64_tr_b16 v[56:57], v12 offset:30720
    ds_read_b64_tr_b16 v[58:59], v12 offset:32000
    ds_read_b64_tr_b16 v[44:45], v11 offset:35840
    ds_read_b64_tr_b16 v[46:47], v11 offset:37120
    ds_read_b64_tr_b16 v[60:61], v12 offset:35840
    ds_read_b64_tr_b16 v[62:63], v12 offset:37120
    s_waitcnt lgkmcnt(12)
    v_mfma_f32_32x32x16_bf16 v[16:31], v[32:35], v[48:51], v[16:31]
    s_waitcnt lgkmcnt(8)
    v_mfma_f32_32x32x16_bf16 v[16:31], v[36:39], v[52:55], v[16:31]
    s_waitcnt lgkmcnt(4)
    v_mfma_f32_32x32x16_bf16 v[16:31], v[40:43], v[56:59], v[16:31]
    s_waitcnt lgkmcnt(0)
    v_mfma_f32_32x32x16_bf16 v[16:31], v[44:47], v[60:63], v[16:31]
    s_waitcnt vmcnt(28)
    ds_write_b128 v10, v[160:163] offset:0
    ds_write_b128 v10, v[164:167] offset:10240
    ds_write_b128 v10, v[168:171] offset:128
    ds_write_b128 v10, v[172:175] offset:10368
    s_waitcnt lgkmcnt(0)
    buffer_load_dwordx4 v[160:163], v6, s[8:11], s34 offen
    buffer_load_dwordx4 v[164:167], v7, s[8:11], s34 offen
    buffer_load_dwordx4 v[168:171], v8, s[12:15], s35 offen
    buffer_load_dwordx4 v[172:175], v9, s[12:15], s35 offen
    s_add_u32 s34, s34, 81920
    s_add_u32 s35, s35, 262144
    s_barrier
    ds_read_b64_tr_b16 v[32:33], v11 offset:0
    ds_read_b64_tr_b16 v[34:35], v11 offset:1280
    ds_read_b64_tr_b16 v[48:49], v12 offset:0
    ds_read_b64_tr_b16 v[50:51], v12 offset:1280
    ds_read_b64_tr_b16 v[36:37], v11 offset:5120
    ds_read_b64_tr_b16 v[38:39], v11 offset:6400
    ds_read_b64_tr_b16 v[52:53], v12 offset:5120
    ds_read_b64_tr_b16 v[54:55], v12 offset:6400
    ds_read_b64_tr_b16 v[40:41], v11 offset:10240
    ds_read_b64_tr_b16 v[42:43], v11 offset:11520
    ds_read_b64_tr_b16 v[56:57], v12 offset:10240
    ds_read_b64_tr_b16 v[58:59], v12 offset:11520
    ds_read_b64_tr_b16 v[44:45], v11 offset:15360
    ds_read_b64_tr_b16 v[46:47], v11 offset:16640
    ds_read_b64_tr_b16 v[60:61], v12 offset:15360
    ds_read_b64_tr_b16 v[62:63], v12 offset:16640
    s_waitcnt lgkmcnt(12)
    v_mfma_f32_32x32x16_bf16 v[16:31], v[32:35], v[48:51], v[16:31]
    s_waitcnt lgkmcnt(8)
    v_mfma_f32_32x32x16_bf16 v[16:31], v[36:39], v[52:55], v[16:31]
    s_waitcnt lgkmcnt(4)
    v_mfma_f32_32x32x16_bf16 v[16:31], v[40:43], v[56:59], v[16:31]
    s_waitcnt lgkmcnt(0)
    v_mfma_f32_32x32x16_bf16 v[16:31], v[44:47], v[60:63], v[16:31]
    s_waitcnt vmcnt(28)
    ds_write_b128 v10, v[176:179] offset:20480
    ds_write_b128 v10, v[180:183] offset:30720
    ds_write_b128 v10, v[184:187] offset:20608
    ds_write_b128 v10, v[188:191] offset:30848
    s_waitcnt lgkmcnt(0)
    buffer_load_dwordx4 v[176:179], v6, s[8:11], s34 offen
    buffer_load_dwordx4 v[180:183], v7, s[8:11], s34 offen
    buffer_load_dwordx4 v[184:187], v8, s[12:15], s35 offen
    buffer_load_dwordx4 v[188:191], v9, s[12:15], s35 offen
    s_add_u32 s34, s34, 81920
    s_add_u32 s35, s35, 262144
    s_barrier
    ds_read_b64_tr_b16 v[32:33], v11 offset:20480
    ds_read_b64_tr_b16 v[34:35], v11 offset:21760
    ds_read_b64_tr_b16 v[48:49], v12 offset:20480
    ds_read_b64_tr_b16 v[50:51], v12 offset:21760
    ds_read_b64_tr_b16 v[36:37], v11 offset:25600
    ds_read_b64_tr_b16 v[38:39], v11 offset:26880
    ds_read_b64_tr_b16 v[52:53], v12 offset:25600
    ds_read_b64_tr_b16 v[54:55], v12 offset:26880
    ds_read_b64_tr_b16 v[40:41], v11 offset:30720
    ds_read_b64_tr_b16 v[42:43], v11 offset:32000
    ds_read_b64_tr_b16 v[56:57], v12 offset:30720
    ds_read_b64_tr_b16 v[58:59], v12 offset:32000
    ds_read_b64_tr_b16 v[44:45], v11 offset:35840
    ds_read_b64_tr_b16 v[46:47], v11 offset:37120
    ds_read_b64_tr_b16 v[60:61], v12 offset:35840
    ds_read_b64_tr_b16 v[62:63], v12 offset:37120
    s_waitcnt lgkmcnt(12)
    v_mfma_f32_32x32x16_bf16 v[16:31], v[32:35], v[48:51], v[16:31]
    s_waitcnt lgkmcnt(8)
    v_mfma_f32_32x32x16_bf16 v[16:31], v[36:39], v[52:55], v[16:31]
    s_waitcnt lgkmcnt(4)
    v_mfma_f32_32x32x16_bf16 v[16:31], v[40:43], v[56:59], v[16:31]
    s_waitcnt lgkmcnt(0)
    v_mfma_f32_32x32x16_bf16 v[16:31], v[44:47], v[60:63], v[16:31]
    s_waitcnt vmcnt(28)
    ds_write_b128 v10, v[64:67] offset:0
    ds_write_b128 v10, v[68:71] offset:10240
    ds_write_b128 v10, v[72:75] offset:128
    ds_write_b128 v10, v[76:79] offset:10368
    s_waitcnt lgkmcnt(0)
    s_barrier
    ds_read_b64_tr_b16 v[32:33], v11 offset:0
    ds_read_b64_tr_b16 v[34:35], v11 offset:1280
    ds_read_b64_tr_b16 v[48:49], v12 offset:0
    ds_read_b64_tr_b16 v[50:51], v12 offset:1280
    ds_read_b64_tr_b16 v[36:37], v11 offset:5120
    ds_read_b64_tr_b16 v[38:39], v11 offset:6400
    ds_read_b64_tr_b16 v[52:53], v12 offset:5120
    ds_read_b64_tr_b16 v[54:55], v12 offset:6400
    ds_read_b64_tr_b16 v[40:41], v11 offset:10240
    ds_read_b64_tr_b16 v[42:43], v11 offset:11520
    ds_read_b64_tr_b16 v[56:57], v12 offset:10240
    ds_read_b64_tr_b16 v[58:59], v12 offset:11520
    ds_read_b64_tr_b16 v[44:45], v11 offset:15360
    ds_read_b64_tr_b16 v[46:47], v11 offset:16640
    ds_read_b64_tr_b16 v[60:61], v12 offset:15360
    ds_read_b64_tr_b16 v[62:63], v12 offset:16640
    s_waitcnt lgkmcnt(12)
    v_mfma_f32_32x32x16_bf16 v[16:31], v[32:35], v[48:51], v[16:31]
    s_waitcnt lgkmcnt(8)
    v_mfma_f32_32x32x16_bf16 v[16:31], v[36:39], v[52:55], v[16:31]
    s_waitcnt lgkmcnt(4)
    v_mfma_f32_32x32x16_bf16 v[16:31], v[40:43], v[56:59], v[16:31]
    s_waitcnt lgkmcnt(0)
    v_mfma_f32_32x32x16_bf16 v[16:31], v[44:47], v[60:63], v[16:31]
    s_waitcnt vmcnt(24)
    ds_write_b128 v10, v[80:83] offset:20480
    ds_write_b128 v10, v[84:87] offset:30720
    ds_write_b128 v10, v[88:91] offset:20608
    ds_write_b128 v10, v[92:95] offset:30848
    s_waitcnt lgkmcnt(0)
    s_barrier
    ds_read_b64_tr_b16 v[32:33], v11 offset:20480
    ds_read_b64_tr_b16 v[34:35], v11 offset:21760
    ds_read_b64_tr_b16 v[48:49], v12 offset:20480
    ds_read_b64_tr_b16 v[50:51], v12 offset:21760
    ds_read_b64_tr_b16 v[36:37], v11 offset:25600
    ds_read_b64_tr_b16 v[38:39], v11 offset:26880
    ds_read_b64_tr_b16 v[52:53], v12 offset:25600
    ds_read_b64_tr_b16 v[54:55], v12 offset:26880
    ds_read_b64_tr_b16 v[40:41], v11 offset:30720
    ds_read_b64_tr_b16 v[42:43], v11 offset:32000
    ds_read_b64_tr_b16 v[56:57], v12 offset:30720
    ds_read_b64_tr_b16 v[58:59], v12 offset:32000
    ds_read_b64_tr_b16 v[44:45], v11 offset:35840
    ds_read_b64_tr_b16 v[46:47], v11 offset:37120
    ds_read_b64_tr_b16 v[60:61], v12 offset:35840
    ds_read_b64_tr_b16 v[62:63], v12 offset:37120
    s_waitcnt lgkmcnt(12)
    v_mfma_f32_32x32x16_bf16 v[16:31], v[32:35], v[48:51], v[16:31]
    s_waitcnt lgkmcnt(8)
    v_mfma_f32_32x32x16_bf16 v[16:31], v[36:39], v[52:55], v[16:31]
    s_waitcnt lgkmcnt(4)
    v_mfma_f32_32x32x16_bf16 v[16:31], v[40:43], v[56:59], v[16:31]
    s_waitcnt lgkmcnt(0)
    v_mfma_f32_32x32x16_bf16 v[16:31], v[44:47], v[60:63], v[16:31]
    s_waitcnt vmcnt(20)
    ds_write_b128 v10, v[96:99] offset:0
    ds_write_b128 v10, v[100:103] offset:10240
    ds_write_b128 v10, v[104:107] offset:128
    ds_write_b128 v10, v[108:111] offset:10368
    s_waitcnt lgkmcnt(0)
    s_barrier
    ds_read_b64_tr_b16 v[32:33], v11 offset:0
    ds_read_b64_tr_b16 v[34:35], v11 offset:1280
    ds_read_b64_tr_b16 v[48:49], v12 offset:0
    ds_read_b64_tr_b16 v[50:51], v12 offset:1280
    ds_read_b64_tr_b16 v[36:37], v11 offset:5120
    ds_read_b64_tr_b16 v[38:39], v11 offset:6400
    ds_read_b64_tr_b16 v[52:53], v12 offset:5120
    ds_read_b64_tr_b16 v[54:55], v12 offset:6400
    ds_read_b64_tr_b16 v[40:41], v11 offset:10240
    ds_read_b64_tr_b16 v[42:43], v11 offset:11520
    ds_read_b64_tr_b16 v[56:57], v12 offset:10240
    ds_read_b64_tr_b16 v[58:59], v12 offset:11520
    ds_read_b64_tr_b16 v[44:45], v11 offset:15360
    ds_read_b64_tr_b16 v[46:47], v11 offset:16640
    ds_read_b64_tr_b16 v[60:61], v12 offset:15360
    ds_read_b64_tr_b16 v[62:63], v12 offset:16640
    s_waitcnt lgkmcnt(12)
    v_mfma_f32_32x32x16_bf16 v[16:31], v[32:35], v[48:51], v[16:31]
    s_waitcnt lgkmcnt(8)
    v_mfma_f32_32x32x16_bf16 v[16:31], v[36:39], v[52:55], v[16:31]
    s_waitcnt lgkmcnt(4)
    v_mfma_f32_32x32x16_bf16 v[16:31], v[40:43], v[56:59], v[16:31]
    s_waitcnt lgkmcnt(0)
    v_mfma_f32_32x32x16_bf16 v[16:31], v[44:47], v[60:63], v[16:31]
    s_waitcnt vmcnt(16)
    ds_write_b128 v10, v[112:115] offset:20480
    ds_write_b128 v10, v[116:119] offset:30720
    ds_write_b128 v10, v[120:123] offset:20608
    ds_write_b128 v10, v[124:127] offset:30848
    s_waitcnt lgkmcnt(0)
    s_barrier
    ds_read_b64_tr_b16 v[32:33], v11 offset:20480
    ds_read_b64_tr_b16 v[34:35], v11 offset:21760
    ds_read_b64_tr_b16 v[48:49], v12 offset:20480
    ds_read_b64_tr_b16 v[50:51], v12 offset:21760
    ds_read_b64_tr_b16 v[36:37], v11 offset:25600
    ds_read_b64_tr_b16 v[38:39], v11 offset:26880
    ds_read_b64_tr_b16 v[52:53], v12 offset:25600
    ds_read_b64_tr_b16 v[54:55], v12 offset:26880
    ds_read_b64_tr_b16 v[40:41], v11 offset:30720
    ds_read_b64_tr_b16 v[42:43], v11 offset:32000
    ds_read_b64_tr_b16 v[56:57], v12 offset:30720
    ds_read_b64_tr_b16 v[58:59], v12 offset:32000
    ds_read_b64_tr_b16 v[44:45], v11 offset:35840
    ds_read_b64_tr_b16 v[46:47], v11 offset:37120
    ds_read_b64_tr_b16 v[60:61], v12 offset:35840
    ds_read_b64_tr_b16 v[62:63], v12 offset:37120
    s_waitcnt lgkmcnt(12)
    v_mfma_f32_32x32x16_bf16 v[16:31], v[32:35], v[48:51], v[16:31]
    s_waitcnt lgkmcnt(8)
    v_mfma_f32_32x32x16_bf16 v[16:31], v[36:39], v[52:55], v[16:31]
    s_waitcnt lgkmcnt(4)
    v_mfma_f32_32x32x16_bf16 v[16:31], v[40:43], v[56:59], v[16:31]
    s_waitcnt lgkmcnt(0)
    v_mfma_f32_32x32x16_bf16 v[16:31], v[44:47], v[60:63], v[16:31]
    s_waitcnt vmcnt(12)
    ds_write_b128 v10, v[128:131] offset:0
    ds_write_b128 v10, v[132:135] offset:10240
    ds_write_b128 v10, v[136:139] offset:128
    ds_write_b128 v10, v[140:143] offset:10368
    s_waitcnt lgkmcnt(0)
    s_barrier
    ds_read_b64_tr_b16 v[32:33], v11 offset:0
    ds_read_b64_tr_b16 v[34:35], v11 offset:1280
    ds_read_b64_tr_b16 v[48:49], v12 offset:0
    ds_read_b64_tr_b16 v[50:51], v12 offset:1280
    ds_read_b64_tr_b16 v[36:37], v11 offset:5120
    ds_read_b64_tr_b16 v[38:39], v11 offset:6400
    ds_read_b64_tr_b16 v[52:53], v12 offset:5120
    ds_read_b64_tr_b16 v[54:55], v12 offset:6400
    ds_read_b64_tr_b16 v[40:41], v11 offset:10240
    ds_read_b64_tr_b16 v[42:43], v11 offset:11520
    ds_read_b64_tr_b16 v[56:57], v12 offset:10240
    ds_read_b64_tr_b16 v[58:59], v12 offset:11520
    ds_read_b64_tr_b16 v[44:45], v11 offset:15360
    ds_read_b64_tr_b16 v[46:47], v11 offset:16640
    ds_read_b64_tr_b16 v[60:61], v12 offset:15360
    ds_read_b64_tr_b16 v[62:63], v12 offset:16640
    s_waitcnt lgkmcnt(12)
    v_mfma_f32_32x32x16_bf16 v[16:31], v[32:35], v[48:51], v[16:31]
    s_waitcnt lgkmcnt(8)
    v_mfma_f32_32x32x16_bf16 v[16:31], v[36:39], v[52:55], v[16:31]
    s_waitcnt lgkmcnt(4)
    v_mfma_f32_32x32x16_bf16 v[16:31], v[40:43], v[56:59], v[16:31]
    s_waitcnt lgkmcnt(0)
    v_mfma_f32_32x32x16_bf16 v[16:31], v[44:47], v[60:63], v[16:31]
    s_waitcnt vmcnt(8)
    ds_write_b128 v10, v[144:147] offset:20480
    ds_write_b128 v10, v[148:151] offset:30720
    ds_write_b128 v10, v[152:155] offset:20608
    ds_write_b128 v10, v[156:159] offset:30848
    s_waitcnt lgkmcnt(0)
    s_barrier
    ds_read_b64_tr_b16 v[32:33], v11 offset:20480
    ds_read_b64_tr_b16 v[34:35], v11 offset:21760
    ds_read_b64_tr_b16 v[48:49], v12 offset:20480
    ds_read_b64_tr_b16 v[50:51], v12 offset:21760
    ds_read_b64_tr_b16 v[36:37], v11 offset:25600
    ds_read_b64_tr_b16 v[38:39], v11 offset:26880
    ds_read_b64_tr_b16 v[52:53], v12 offset:25600
    ds_read_b64_tr_b16 v[54:55], v12 offset:26880
    ds_read_b64_tr_b16 v[40:41], v11 offset:30720
    ds_read_b64_tr_b16 v[42:43], v11 offset:32000
    ds_read_b64_tr_b16 v[56:57], v12 offset:30720
    ds_read_b64_tr_b16 v[58:59], v12 offset:32000
    ds_read_b64_tr_b16 v[44:45], v11 offset:35840
    ds_read_b64_tr_b16 v[46:47], v11 offset:37120
    ds_read_b64_tr_b16 v[60:61], v12 offset:35840
    ds_read_b64_tr_b16 v[62:63], v12 offset:37120
    s_waitcnt lgkmcnt(12)
    v_mfma_f32_32x32x16_bf16 v[16:31], v[32:35], v[48:51], v[16:31]
    s_waitcnt lgkmcnt(8)
    v_mfma_f32_32x32x16_bf16 v[16:31], v[36:39], v[52:55], v[16:31]
    s_waitcnt lgkmcnt(4)
    v_mfma_f32_32x32x16_bf16 v[16:31], v[40:43], v[56:59], v[16:31]
    s_waitcnt lgkmcnt(0)
    v_mfma_f32_32x32x16_bf16 v[16:31], v[44:47], v[60:63], v[16:31]
    s_waitcnt vmcnt(4)
    ds_write_b128 v10, v[160:163] offset:0
    ds_write_b128 v10, v[164:167] offset:10240
    ds_write_b128 v10, v[168:171] offset:128
    ds_write_b128 v10, v[172:175] offset:10368
    s_waitcnt lgkmcnt(0)
    s_barrier
    ds_read_b64_tr_b16 v[32:33], v11 offset:0
    ds_read_b64_tr_b16 v[34:35], v11 offset:1280
    ds_read_b64_tr_b16 v[48:49], v12 offset:0
    ds_read_b64_tr_b16 v[50:51], v12 offset:1280
    ds_read_b64_tr_b16 v[36:37], v11 offset:5120
    ds_read_b64_tr_b16 v[38:39], v11 offset:6400
    ds_read_b64_tr_b16 v[52:53], v12 offset:5120
    ds_read_b64_tr_b16 v[54:55], v12 offset:6400
    ds_read_b64_tr_b16 v[40:41], v11 offset:10240
    ds_read_b64_tr_b16 v[42:43], v11 offset:11520
    ds_read_b64_tr_b16 v[56:57], v12 offset:10240
    ds_read_b64_tr_b16 v[58:59], v12 offset:11520
    ds_read_b64_tr_b16 v[44:45], v11 offset:15360
    ds_read_b64_tr_b16 v[46:47], v11 offset:16640
    ds_read_b64_tr_b16 v[60:61], v12 offset:15360
    ds_read_b64_tr_b16 v[62:63], v12 offset:16640
    s_waitcnt lgkmcnt(12)
    v_mfma_f32_32x32x16_bf16 v[16:31], v[32:35], v[48:51], v[16:31]
    s_waitcnt lgkmcnt(8)
    v_mfma_f32_32x32x16_bf16 v[16:31], v[36:39], v[52:55], v[16:31]
    s_waitcnt lgkmcnt(4)
    v_mfma_f32_32x32x16_bf16 v[16:31], v[40:43], v[56:59], v[16:31]
    s_waitcnt lgkmcnt(0)
    v_mfma_f32_32x32x16_bf16 v[16:31], v[44:47], v[60:63], v[16:31]
    s_waitcnt vmcnt(0)
    ds_write_b128 v10, v[176:179] offset:20480
    ds_write_b128 v10, v[180:183] offset:30720
    ds_write_b128 v10, v[184:187] offset:20608
    ds_write_b128 v10, v[188:191] offset:30848
    s_waitcnt lgkmcnt(0)
    s_barrier
    ds_read_b64_tr_b16 v[32:33], v11 offset:20480
    ds_read_b64_tr_b16 v[34:35], v11 offset:21760
    ds_read_b64_tr_b16 v[48:49], v12 offset:20480
    ds_read_b64_tr_b16 v[50:51], v12 offset:21760
    ds_read_b64_tr_b16 v[36:37], v11 offset:25600
    ds_read_b64_tr_b16 v[38:39], v11 offset:26880
    ds_read_b64_tr_b16 v[52:53], v12 offset:25600
    ds_read_b64_tr_b16 v[54:55], v12 offset:26880
    ds_read_b64_tr_b16 v[40:41], v11 offset:30720
    ds_read_b64_tr_b16 v[42:43], v11 offset:32000
    ds_read_b64_tr_b16 v[56:57], v12 offset:30720
    ds_read_b64_tr_b16 v[58:59], v12 offset:32000
    ds_read_b64_tr_b16 v[44:45], v11 offset:35840
    ds_read_b64_tr_b16 v[46:47], v11 offset:37120
    ds_read_b64_tr_b16 v[60:61], v12 offset:35840
    ds_read_b64_tr_b16 v[62:63], v12 offset:37120
    s_waitcnt lgkmcnt(12)
    v_mfma_f32_32x32x16_bf16 v[16:31], v[32:35], v[48:51], v[16:31]
    s_waitcnt lgkmcnt(8)
    v_mfma_f32_32x32x16_bf16 v[16:31], v[36:39], v[52:55], v[16:31]
    s_waitcnt lgkmcnt(4)
    v_mfma_f32_32x32x16_bf16 v[16:31], v[40:43], v[56:59], v[16:31]
    s_waitcnt lgkmcnt(0)
    v_mfma_f32_32x32x16_bf16 v[16:31], v[44:47], v[60:63], v[16:31]
    s_nop 15
    v_and_b32 v3, 31, v1
    v_lshrrev_b32 v4, 1, v2
    v_lshlrev_b32 v4, 5, v4
    v_add_u32 v3, v3, v4
    v_lshlrev_b32 v5, 1, v3
    buffer_load_ushort v13, v5, s[20:23], s33 offen
    v_mul_u32_u24 v6, 1280, v3
    v_and_b32 v4, 1, v2
    v_lshlrev_b32 v4, 6, v4
    v_add_u32 v6, v6, v4
    v_lshrrev_b32 v4, 5, v1
    v_lshlrev_b32 v4, 3, v4
    v_add_u32 v6, v6, v4
    s_mul_i32 s36, s29, 81920
    s_add_u32 s36, s36, s32
    buffer_load_dwordx2 v[64:65], v6, s[16:19], s36 offen offset:0
    buffer_load_dwordx2 v[66:67], v6, s[16:19], s36 offen offset:16
    buffer_load_dwordx2 v[68:69], v6, s[16:19], s36 offen offset:32
    buffer_load_dwordx2 v[70:71], v6, s[16:19], s36 offen offset:48
    s_waitcnt vmcnt(0)
    v_lshlrev_b32 v13, 16, v13
    v_cvt_pk_bf16_f32 v14, v16, v16
    v_lshlrev_b32 v16, 16, v14
    v_add_f32 v16, v16, v13
    v_cvt_pk_bf16_f32 v14, v16, v16
    v_lshlrev_b32 v16, 16, v14
    v_lshlrev_b32 v14, 16, v64
    v_add_f32 v16, v16, v14
    v_cvt_pk_bf16_f32 v14, v17, v17
    v_lshlrev_b32 v17, 16, v14
    v_add_f32 v17, v17, v13
    v_cvt_pk_bf16_f32 v14, v17, v17
    v_lshlrev_b32 v17, 16, v14
    v_and_b32 v14, 0xffff0000, v64
    v_add_f32 v17, v17, v14
    v_cvt_pk_bf16_f32 v14, v18, v18
    v_lshlrev_b32 v18, 16, v14
    v_add_f32 v18, v18, v13
    v_cvt_pk_bf16_f32 v14, v18, v18
    v_lshlrev_b32 v18, 16, v14
    v_lshlrev_b32 v14, 16, v65
    v_add_f32 v18, v18, v14
    v_cvt_pk_bf16_f32 v14, v19, v19
    v_lshlrev_b32 v19, 16, v14
    v_add_f32 v19, v19, v13
    v_cvt_pk_bf16_f32 v14, v19, v19
    v_lshlrev_b32 v19, 16, v14
    v_and_b32 v14, 0xffff0000, v65
    v_add_f32 v19, v19, v14
    v_cvt_pk_bf16_f32 v14, v16, v17
    v_cvt_pk_bf16_f32 v15, v18, v19
    buffer_store_dwordx2 v[14:15], v6, s[44:47], s36 offen offset:0
    s_nop 1
    v_cvt_pk_bf16_f32 v14, v20, v20
    v_lshlrev_b32 v20, 16, v14
    v_add_f32 v20, v20, v13
    v_cvt_pk_bf16_f32 v14, v20, v20
    v_lshlrev_b32 v20, 16, v14
    v_lshlrev_b32 v14, 16, v66
    v_add_f32 v20, v20, v14
    v_cvt_pk_bf16_f32 v14, v21, v21
    v_lshlrev_b32 v21, 16, v14
    v_add_f32 v21, v21, v13
    v_cvt_pk_bf16_f32 v14, v21, v21
    v_lshlrev_b32 v21, 16, v14
    v_and_b32 v14, 0xffff0000, v66
    v_add_f32 v21, v21, v14
    v_cvt_pk_bf16_f32 v14, v22, v22
    v_lshlrev_b32 v22, 16, v14
    v_add_f32 v22, v22, v13
    v_cvt_pk_bf16_f32 v14, v22, v22
    v_lshlrev_b32 v22, 16, v14
    v_lshlrev_b32 v14, 16, v67
    v_add_f32 v22, v22, v14
    v_cvt_pk_bf16_f32 v14, v23, v23
    v_lshlrev_b32 v23, 16, v14
    v_add_f32 v23, v23, v13
    v_cvt_pk_bf16_f32 v14, v23, v23
    v_lshlrev_b32 v23, 16, v14
    v_and_b32 v14, 0xffff0000, v67
    v_add_f32 v23, v23, v14
    v_cvt_pk_bf16_f32 v14, v20, v21
    v_cvt_pk_bf16_f32 v15, v22, v23
    buffer_store_dwordx2 v[14:15], v6, s[44:47], s36 offen offset:16
    s_nop 1
    v_cvt_pk_bf16_f32 v14, v24, v24
    v_lshlrev_b32 v24, 16, v14
    v_add_f32 v24, v24, v13
    v_cvt_pk_bf16_f32 v14, v24, v24
    v_lshlrev_b32 v24, 16, v14
    v_lshlrev_b32 v14, 16, v68
    v_add_f32 v24, v24, v14
    v_cvt_pk_bf16_f32 v14, v25, v25
    v_lshlrev_b32 v25, 16, v14
    v_add_f32 v25, v25, v13
    v_cvt_pk_bf16_f32 v14, v25, v25
    v_lshlrev_b32 v25, 16, v14
    v_and_b32 v14, 0xffff0000, v68
    v_add_f32 v25, v25, v14
    v_cvt_pk_bf16_f32 v14, v26, v26
    v_lshlrev_b32 v26, 16, v14
    v_add_f32 v26, v26, v13
    v_cvt_pk_bf16_f32 v14, v26, v26
    v_lshlrev_b32 v26, 16, v14
    v_lshlrev_b32 v14, 16, v69
    v_add_f32 v26, v26, v14
    v_cvt_pk_bf16_f32 v14, v27, v27
    v_lshlrev_b32 v27, 16, v14
    v_add_f32 v27, v27, v13
    v_cvt_pk_bf16_f32 v14, v27, v27
    v_lshlrev_b32 v27, 16, v14
    v_and_b32 v14, 0xffff0000, v69
    v_add_f32 v27, v27, v14
    v_cvt_pk_bf16_f32 v14, v24, v25
    v_cvt_pk_bf16_f32 v15, v26, v27
    buffer_store_dwordx2 v[14:15], v6, s[44:47], s36 offen offset:32
    s_nop 1
    v_cvt_pk_bf16_f32 v14, v28, v28
    v_lshlrev_b32 v28, 16, v14
    v_add_f32 v28, v28, v13
    v_cvt_pk_bf16_f32 v14, v28, v28
    v_lshlrev_b32 v28, 16, v14
    v_lshlrev_b32 v14, 16, v70
    v_add_f32 v28, v28, v14
    v_cvt_pk_bf16_f32 v14, v29, v29
    v_lshlrev_b32 v29, 16, v14
    v_add_f32 v29, v29, v13
    v_cvt_pk_bf16_f32 v14, v29, v29
    v_lshlrev_b32 v29, 16, v14
    v_and_b32 v14, 0xffff0000, v70
    v_add_f32 v29, v29, v14
    v_cvt_pk_bf16_f32 v14, v30, v30
    v_lshlrev_b32 v30, 16, v14
    v_add_f32 v30, v30, v13
    v_cvt_pk_bf16_f32 v14, v30, v30
    v_lshlrev_b32 v30, 16, v14
    v_lshlrev_b32 v14, 16, v71
    v_add_f32 v30, v30, v14
    v_cvt_pk_bf16_f32 v14, v31, v31
    v_lshlrev_b32 v31, 16, v14
    v_add_f32 v31, v31, v13
    v_cvt_pk_bf16_f32 v14, v31, v31
    v_lshlrev_b32 v31, 16, v14
    v_and_b32 v14, 0xffff0000, v71
    v_add_f32 v31, v31, v14
    v_cvt_pk_bf16_f32 v14, v28, v29
    v_cvt_pk_bf16_f32 v15, v30, v31
    buffer_store_dwordx2 v[14:15], v6, s[44:47], s36 offen offset:48
    s_nop 1
L_k5_end:
    s_endpgm
.section .rodata,"a"
.p2align 6
.amdhsa_kernel k0_ln1_kernel
  .amdhsa_next_free_vgpr 96
  .amdhsa_next_free_sgpr 32
  .amdhsa_accum_offset 96
  .amdhsa_group_segment_fixed_size 0
  .amdhsa_kernarg_size 120
  .amdhsa_user_sgpr_count 2
  .amdhsa_user_sgpr_kernarg_segment_ptr 1
  .amdhsa_system_sgpr_workgroup_id_x 1
.end_amdhsa_kernel
.p2align 6
.amdhsa_kernel kc_kgenconv_kernel
  .amdhsa_next_free_vgpr 168
  .amdhsa_next_free_sgpr 64
  .amdhsa_accum_offset 168
  .amdhsa_group_segment_fixed_size 0
  .amdhsa_kernarg_size 120
  .amdhsa_user_sgpr_count 2
  .amdhsa_user_sgpr_kernarg_segment_ptr 1
  .amdhsa_system_sgpr_workgroup_id_x 1
.end_amdhsa_kernel
.p2align 6
.amdhsa_kernel k3_ln2_kernel
  .amdhsa_next_free_vgpr 112
  .amdhsa_next_free_sgpr 32
  .amdhsa_accum_offset 112
  .amdhsa_group_segment_fixed_size 0
  .amdhsa_kernarg_size 120
  .amdhsa_user_sgpr_count 2
  .amdhsa_user_sgpr_kernarg_segment_ptr 1
  .amdhsa_system_sgpr_workgroup_id_x 1
.end_amdhsa_kernel
.p2align 6
.amdhsa_kernel k4_gemm1_kernel
  .amdhsa_next_free_vgpr 192
  .amdhsa_next_free_sgpr 40
  .amdhsa_accum_offset 192
  .amdhsa_group_segment_fixed_size 0
  .amdhsa_kernarg_size 120
  .amdhsa_user_sgpr_count 2
  .amdhsa_user_sgpr_kernarg_segment_ptr 1
  .amdhsa_system_sgpr_workgroup_id_x 1
.end_amdhsa_kernel
.p2align 6
.amdhsa_kernel k5_gemm2_kernel
  .amdhsa_next_free_vgpr 192
  .amdhsa_next_free_sgpr 48
  .amdhsa_accum_offset 192
  .amdhsa_group_segment_fixed_size 0
  .amdhsa_kernarg_size 120
  .amdhsa_user_sgpr_count 2
  .amdhsa_user_sgpr_kernarg_segment_ptr 1
  .amdhsa_system_sgpr_workgroup_id_x 1
.end_amdhsa_kernel
```
